```python
import torch

def _softmax(x, axis=-1):
    return torch.softmax(x, dim=axis)
def _gelu(x):
    return torch.nn.functional.gelu(x, approximate="tanh")
def _silu(x):
    return torch.nn.functional.silu(x)
def _sigmoid(x):
    return torch.sigmoid(x)
def _layernorm(x, axis=-1, eps=1e-5):
    m = x.mean(dim=axis, keepdim=True)
    v = x.var(dim=axis, keepdim=True, unbiased=False)
    return (x - m) / torch.sqrt(v + eps)
def _scatter_add(tgt, idx, src, axis=0):
    return tgt.clone().index_add_(axis, idx, src)
def _segment_sum(src, seg, n):
    out = torch.zeros((n,) + src.shape[1:], dtype=src.dtype)
    return out.index_add_(0, seg, src)
def _pad(x, pw):
    flat = tuple(v for pair in reversed(pw) for v in pair)
    return torch.nn.functional.pad(x, flat)

kernel_name = 'standalone__deep_cross_pnn__recsys'

def setup_inputs():

    _w = (lambda a: (lambda t: t.to(torch.bfloat16) if t.is_floating_point() else t)(torch.as_tensor(a)))
    B, F, D, V = 4096, 100, 64, min(100000, 100000)
    H = 4 * D
    return {
        "idx": _w((lambda lo, hi, *s: torch.randint(lo, hi, s))(0, V, B, F).to(torch.int64)),
        "table": _w((lambda *s: torch.randn(*s, dtype=torch.bfloat16) * 1.6)(V, D) * (D ** -0.5)),
        "w_p": _w((lambda *s: torch.randn(*s, dtype=torch.bfloat16) * 0.05)(F * F) * ((F * F) ** -0.5)),
        "w1": _w((lambda *s: torch.randn(*s, dtype=torch.bfloat16) * 1.6)(F * D, H) * ((F * D) ** -0.5)),
        "b1": _w((lambda *s: torch.randn(*s, dtype=torch.bfloat16) * 12.8)(H) * 0.01),
        "w2": _w((lambda *s: torch.randn(*s, dtype=torch.bfloat16) * 0.05)(H) * (H ** -0.5)),
        "b2": _w((lambda *s: torch.randn(*s, dtype=torch.bfloat16) * 3.2)(1) * 0.01),
    }

def reference(idx, table, w_p, w1, b1, w2, b2):
    emb = table[idx]
    B = emb.shape[0]; F = emb.shape[1]; D = emb.shape[2]
    ip = torch.einsum('bid,bjd->bij', emb, emb)
    ip = ip.reshape(B, F * F)
    logit_p = ip @ w_p
    z = emb.reshape(B, F * D)
    h = _gelu(z @ w1 + b1)
    logit_d = h @ w2 + b2
    return logit_p + logit_d
```

```asm
; @launch grid=(256,1,1) block=(512,1,1) lds=163840
.amdgcn_target "amdgcn-amd-amdhsa--gfx950"
.text
.globl standalone__deep_cross_pnn__recsys_kernel
.p2align 8
.type standalone__deep_cross_pnn__recsys_kernel,@function
standalone__deep_cross_pnn__recsys_kernel:
    s_cmp_ge_u32 s2, 256
    s_cbranch_scc1 Lnn__recsys_END
    s_load_dwordx16 s[4:19], s[0:1], 0
    s_load_dwordx4 s[20:23], s[0:1], 64
    v_lshrrev_b32 v1, 6, v0
    s_and_b32 s64, s2, 7
    s_lshl_b32 s64, s64, 2
    v_readfirstlane_b32 s69, v1
    s_lshr_b32 s70, s2, 6
    s_add_u32 s64, s64, s70
    s_lshr_b32 s67, s2, 3
    s_and_b32 s67, s67, 7
    s_and_b32 s65, s67, 3
    s_lshr_b32 s66, s67, 2
    s_lshl_b32 s68, s64, 7
    v_and_b32 v250, 63, v0
    s_cmp_ge_u32 s69, 4
    s_cbranch_scc1 Lnn__recsys_CSTART
    s_lshr_b32 s94, s2, 6
    s_xor_b32 s94, s94, s66
    s_and_b32 s94, s94, 1
    s_and_b32 s70, s65, 1
    s_and_b32 s70, s70, s94
    s_sub_u32 s94, s94, s70
    s_sub_u32 s99, s94, s70
    v_lshrrev_b32 v220, 3, v250
    v_and_b32 v221, 7, v250
    v_mul_u32_u24 v222, 37, v250
    v_lshrrev_b32 v222, 8, v222
    v_mul_u32_u24 v225, 288, v222
    v_lshl_add_u32 v225, v250, 4, v225
    v_lshlrev_b32 v226, 4, v250
    v_lshrrev_b32 v222, 4, v250
    v_lshlrev_b32 v223, 2, v222
    v_and_b32 v224, 15, v250
    v_xor_b32 v224, v224, v223
    v_lshlrev_b32 v224, 4, v224
    v_lshl_add_u32 v236, v222, 9, v224
    v_xor_b32 v237, 32, v236
    s_lshl_b32 s73, s69, 12
    s_add_u32 s75, s73, 65536
    s_mul_i32 s72, s65, 819200
    s_lshl_b32 s70, s66, 8
    s_add_u32 s72, s72, s70
    s_lshl_b32 s70, s69, 13
    s_add_u32 s72, s72, s70
    s_lshl_b32 s70, s94, 15
    s_add_u32 s95, s72, s70
    s_sub_u32 s96, s72, s70
    s_lshl_b32 s70, s99, 15
    s_add_u32 s100, s72, s70
    s_sub_u32 s101, s72, s70
    s_lshl_b32 s97, s94, 2
    s_lshl_b32 s98, s99, 2
    s_lshl_b32 s70, s69, 5
    s_add_u32 s70, s70, s68
    s_mul_i32 s70, s70, 400
    s_mul_i32 s71, s65, 100
    s_add_u32 s70, s70, s71
    s_lshl_b32 s77, s67, 4
    s_lshl_b32 s78, s69, 2
    s_add_u32 s77, s77, s78
    s_add_u32 s78, s77, s68
    s_mul_i32 s78, s78, 400
    s_add_u32 s79, s73, 98304
    s_waitcnt lgkmcnt(0)
    s_mov_b32 s24, s4
    s_mov_b32 s25, s5
    s_mov_b32 s26, 1638400
    s_mov_b32 s27, 0x20000
    s_add_u32 m0, s73, 49152
    s_nop 0
    buffer_load_dwordx4 v225, s[24:27], s70 offen lds
    s_add_u32 m0, s73, 50176
    s_add_u32 s70, s70, 3200
    buffer_load_dwordx4 v225, s[24:27], s70 offen lds
    s_add_u32 m0, s73, 51200
    s_add_u32 s70, s70, 3200
    buffer_load_dwordx4 v225, s[24:27], s70 offen lds
    s_add_u32 m0, s73, 52224
    s_add_u32 s70, s70, 3200
    buffer_load_dwordx4 v225, s[24:27], s70 offen lds
    s_mov_b32 m0, s79
    s_nop 0
    buffer_load_dwordx4 v226, s[24:27], s78 offen lds
    s_mov_b32 exec_hi, 15
    buffer_load_dwordx4 v226, s[24:27], s78 offen offset:1024 lds
    s_mov_b32 exec_hi, -1
    s_mov_b32 s32, s10
    s_mov_b32 s33, s11
    s_mov_b32 s34, 3276800
    s_mov_b32 s35, 0x20000
    s_add_u32 m0, s75, 0
    s_add_u32 s70, s72, 786432
    buffer_load_dwordx4 v236, s[32:35], s70 offen lds
    s_add_u32 m0, s75, 1024
    s_add_u32 s70, s72, 788480
    buffer_load_dwordx4 v236, s[32:35], s70 offen lds
    s_add_u32 m0, s75, 2048
    s_add_u32 s70, s72, 790528
    buffer_load_dwordx4 v237, s[32:35], s70 offen lds
    s_add_u32 m0, s75, 3072
    s_add_u32 s70, s72, 792576
    buffer_load_dwordx4 v237, s[32:35], s70 offen lds
    s_add_u32 m0, s75, 16384
    s_add_u32 s70, s95, 0
    buffer_load_dwordx4 v236, s[32:35], s70 offen lds
    s_add_u32 m0, s75, 17408
    s_add_u32 s70, s95, 2048
    buffer_load_dwordx4 v236, s[32:35], s70 offen lds
    s_add_u32 m0, s75, 18432
    s_add_u32 s70, s95, 4096
    buffer_load_dwordx4 v237, s[32:35], s70 offen lds
    s_add_u32 m0, s75, 19456
    s_add_u32 s70, s95, 6144
    buffer_load_dwordx4 v237, s[32:35], s70 offen lds
    s_mov_b32 s28, s6
    s_mov_b32 s29, s7
    s_mov_b32 s30, 12800000
    s_mov_b32 s31, 0x20000
    v_lshrrev_b32 v222, 1, v220
    v_xor_b32 v222, v222, v221
    v_lshlrev_b32 v240, 4, v222
    v_xor_b32 v241, 64, v240
    v_mul_u32_u24 v69, 112, v220
    s_add_u32 s70, s73, 49152
    v_add_u32 v69, s70, v69
    v_add_u32 v70, s97, v69
    v_subrev_u32 v71, s97, v69
    v_add_u32 v117, s98, v69
    v_subrev_u32 v163, s98, v69
    v_add_u32 v118, 1024, v117
    v_add_u32 v164, 1024, v163
    v_add_u32 v119, 2048, v117
    v_add_u32 v165, 2048, v163
    v_add_u32 v162, 3072, v117
    v_add_u32 v166, 3072, v163
    v_bfe_u32 v222, v250, 4, 1
    v_and_b32 v223, 3, v250
    v_lshl_add_u32 v222, v222, 2, v223
    v_lshlrev_b32 v242, 4, v222
    v_bfe_u32 v224, v250, 2, 2
    v_mul_u32_u24 v222, 96, v224
    v_add_u32 v222, s79, v222
    v_lshrrev_b32 v223, 5, v250
    v_lshl_add_u32 v114, v223, 3, v222
    v_add_u32 v115, 1200, v114
    v_mul_u32_u24 v223, 800, v223
    v_lshl_add_u32 v223, v224, 2, v223
    v_add_u32 v116, s79, v223
    v_lshrrev_b32 v222, 2, v220
    v_mul_u32_u24 v222, 96, v222
    v_and_b32 v223, 3, v220
    v_lshl_add_u32 v222, v223, 2, v222
    v_add_u32 v167, s79, v222
    v_add_u32 v227, 800, v167
    v_mov_b32 v216, 0
    v_mov_b32 v217, 0
    v_mov_b32 v218, 0
    v_mov_b32 v219, 0
    v_add_u32 v238, 135168, v226
    v_lshlrev_b32 v239, 2, v250
    v_add_u32 v239, 157696, v239
    s_mov_b32 s48, 0x55555555
    s_mov_b32 s49, 0x55555555
    s_mov_b32 s50, 0xaaaaaaaa
    s_mov_b32 s51, 0xaaaaaaaa
    s_mov_b32 s52, 0x33333333
    s_mov_b32 s53, 0x33333333
    s_mov_b32 s54, 0xcccccccc
    s_mov_b32 s55, 0xcccccccc
    s_barrier
    s_waitcnt vmcnt(10)
    ds_read_b32 v204, v69 offset:96
    ds_read_b32 v205, v70 offset:0
    ds_read_b32 v206, v69 offset:1120
    ds_read_b32 v207, v70 offset:1024
    ds_read_b32 v208, v69 offset:2144
    ds_read_b32 v209, v70 offset:2048
    ds_read_b32 v210, v69 offset:3168
    ds_read_b32 v211, v70 offset:3072
    ds_read_b32 v196, v163 offset:4
    ds_read_b32 v198, v163 offset:1028
    ds_read_b32 v200, v163 offset:2052
    ds_read_b32 v202, v163 offset:3076
    s_waitcnt lgkmcnt(10)
    v_lshl_add_u32 v204, v204, 7, v240
    v_lshl_add_u32 v205, v205, 7, v240
    s_add_u32 m0, s73, 0
    s_nop 0
    buffer_load_dwordx4 v204, s[28:31], 0 offen lds
    s_waitcnt lgkmcnt(8)
    v_lshl_add_u32 v206, v206, 7, v241
    v_lshl_add_u32 v207, v207, 7, v241
    s_add_u32 m0, s73, 1024
    s_nop 0
    buffer_load_dwordx4 v206, s[28:31], 0 offen lds
    s_waitcnt lgkmcnt(6)
    v_lshl_add_u32 v208, v208, 7, v240
    v_lshl_add_u32 v209, v209, 7, v240
    s_add_u32 m0, s73, 2048
    s_nop 0
    buffer_load_dwordx4 v208, s[28:31], 0 offen lds
    s_waitcnt lgkmcnt(4)
    v_lshl_add_u32 v210, v210, 7, v241
    v_lshl_add_u32 v211, v211, 7, v241
    s_add_u32 m0, s73, 3072
    s_nop 0
    buffer_load_dwordx4 v210, s[28:31], 0 offen lds
    s_add_u32 m0, s73, 16384
    s_nop 0
    buffer_load_dwordx4 v205, s[28:31], 0 offen lds
    s_add_u32 m0, s73, 17408
    s_nop 0
    buffer_load_dwordx4 v207, s[28:31], 0 offen lds
    s_add_u32 m0, s73, 18432
    s_nop 0
    buffer_load_dwordx4 v209, s[28:31], 0 offen lds
    s_add_u32 m0, s73, 19456
    s_nop 0
    buffer_load_dwordx4 v211, s[28:31], 0 offen lds
    s_waitcnt vmcnt(16)
    s_waitcnt lgkmcnt(3)
    v_lshl_add_u32 v196, v196, 7, v240
    s_waitcnt lgkmcnt(2)
    v_lshl_add_u32 v198, v198, 7, v241
    s_waitcnt lgkmcnt(1)
    v_lshl_add_u32 v200, v200, 7, v240
    s_waitcnt lgkmcnt(0)
    v_lshl_add_u32 v202, v202, 7, v241
    s_add_u32 m0, s73, 32768
    s_nop 0
    buffer_load_dwordx4 v196, s[28:31], 0 offen lds
    s_add_u32 m0, s73, 33792
    s_nop 0
    buffer_load_dwordx4 v198, s[28:31], 0 offen lds
    s_add_u32 m0, s73, 34816
    s_nop 0
    buffer_load_dwordx4 v200, s[28:31], 0 offen lds
    s_add_u32 m0, s73, 35840
    s_nop 0
    buffer_load_dwordx4 v202, s[28:31], 0 offen lds
    ds_read2_b32 v[228:229], v116 offset0:96 offset1:196
    ds_read2_b32 v[0:1], v114 offset0:0 offset1:1
    ds_read2_b32 v[48:49], v114 offset0:100 offset1:101
    ds_read2_b32 v[96:97], v114 offset0:200 offset1:201
    ds_read2_b32 v[144:145], v115 offset0:0 offset1:1
    ds_read2_b32 v[8:9], v114 offset0:4 offset1:5
    ds_read2_b32 v[56:57], v114 offset0:104 offset1:105
    ds_read2_b32 v[104:105], v114 offset0:204 offset1:205
    ds_read2_b32 v[152:153], v115 offset0:4 offset1:5
    ds_read2_b32 v[16:17], v114 offset0:8 offset1:9
    ds_read2_b32 v[64:65], v114 offset0:108 offset1:109
    ds_read2_b32 v[112:113], v114 offset0:208 offset1:209
    ds_read2_b32 v[160:161], v115 offset0:8 offset1:9
    ds_read2_b32 v[24:25], v167 offset0:12 offset1:60
    ds_read2_b32 v[72:73], v167 offset0:112 offset1:160
    ds_read2_b32 v[120:121], v227 offset0:12 offset1:60
    ds_read2_b32 v[168:169], v227 offset0:112 offset1:160
    ds_read2_b32 v[32:33], v167 offset0:16 offset1:64
    ds_read2_b32 v[80:81], v167 offset0:116 offset1:164
    ds_read2_b32 v[128:129], v227 offset0:16 offset1:64
    ds_read2_b32 v[176:177], v227 offset0:116 offset1:164
    ds_read2_b32 v[40:41], v167 offset0:20 offset1:68
    ds_read2_b32 v[88:89], v167 offset0:120 offset1:168
    ds_read2_b32 v[136:137], v227 offset0:20 offset1:68
    ds_read2_b32 v[184:185], v227 offset0:120 offset1:168
    ds_read2_b32 v[252:253], v117 offset0:2 offset1:4
    ds_read2_b32 v[254:255], v118 offset0:2 offset1:4
    ds_read2_b32 v[192:193], v119 offset0:2 offset1:4
    ds_read2_b32 v[194:195], v162 offset0:2 offset1:4
    ds_read2_b32 v[244:245], v163 offset0:3 offset1:5
    ds_read2_b32 v[246:247], v164 offset0:3 offset1:5
    ds_read2_b32 v[248:249], v165 offset0:3 offset1:5
    ds_read2_b32 v[250:251], v166 offset0:3 offset1:5
    s_waitcnt lgkmcnt(8)
    s_add_u32 m0, s75, 32768
    s_add_u32 s70, s101, 32768
    buffer_load_dwordx4 v236, s[32:35], s70 offen lds
    s_add_u32 m0, s75, 33792
    s_add_u32 s70, s101, 34816
    buffer_load_dwordx4 v236, s[32:35], s70 offen lds
    s_add_u32 m0, s75, 34816
    s_add_u32 s70, s101, 36864
    buffer_load_dwordx4 v237, s[32:35], s70 offen lds
    s_add_u32 m0, s75, 35840
    s_add_u32 s70, s101, 38912
    buffer_load_dwordx4 v237, s[32:35], s70 offen lds
    ds_read2_b32 v[142:143], v117 offset0:6 offset1:8
    ds_read2_b32 v[186:187], v118 offset0:6 offset1:8
    ds_read2_b32 v[188:189], v119 offset0:6 offset1:8
    ds_read2_b32 v[190:191], v162 offset0:6 offset1:8
    ds_read2_b32 v[92:93], v163 offset0:7 offset1:9
    ds_read2_b32 v[94:95], v164 offset0:7 offset1:9
    ds_read2_b32 v[138:139], v165 offset0:7 offset1:9
    ds_read2_b32 v[140:141], v166 offset0:7 offset1:9
    ds_read2_b32 v[42:43], v117 offset0:10 offset1:12
    ds_read2_b32 v[44:45], v118 offset0:10 offset1:12
    ds_read2_b32 v[46:47], v119 offset0:10 offset1:12
    ds_read2_b32 v[90:91], v162 offset0:10 offset1:12
    ds_read2_b32 v[134:135], v163 offset0:11 offset1:13
    ds_read2_b32 v[178:179], v164 offset0:11 offset1:13
    ds_read2_b32 v[180:181], v165 offset0:11 offset1:13
    ds_read2_b32 v[182:183], v166 offset0:11 offset1:13
    ds_read2_b32 v[84:85], v117 offset0:14 offset1:16
    ds_read2_b32 v[86:87], v118 offset0:14 offset1:16
    ds_read2_b32 v[130:131], v119 offset0:14 offset1:16
    ds_read2_b32 v[132:133], v162 offset0:14 offset1:16
    ds_read2_b32 v[34:35], v163 offset0:15 offset1:17
    ds_read2_b32 v[36:37], v164 offset0:15 offset1:17
    ds_read2_b32 v[38:39], v165 offset0:15 offset1:17
    ds_read2_b32 v[82:83], v166 offset0:15 offset1:17
    ds_read2_b32 v[126:127], v117 offset0:18 offset1:20
    ds_read2_b32 v[170:171], v118 offset0:18 offset1:20
    ds_read2_b32 v[172:173], v119 offset0:18 offset1:20
    ds_read2_b32 v[174:175], v162 offset0:18 offset1:20
    ds_read2_b32 v[76:77], v163 offset0:19 offset1:21
    ds_read2_b32 v[78:79], v164 offset0:19 offset1:21
    ds_read2_b32 v[122:123], v165 offset0:19 offset1:21
    ds_read2_b32 v[124:125], v166 offset0:19 offset1:21
    ds_read_b32 v26, v117 offset:88
    ds_read_b32 v27, v71 offset:92
    ds_read_b32 v28, v117 offset:1112
    ds_read_b32 v29, v71 offset:1116
    ds_read_b32 v30, v117 offset:2136
    ds_read_b32 v31, v71 offset:2140
    ds_read_b32 v74, v117 offset:3160
    ds_read_b32 v75, v71 offset:3164
    s_waitcnt vmcnt(12)
    s_barrier
    s_add_u32 m0, s73, 49152
    s_waitcnt lgkmcnt(0)
    v_lshl_add_u32 v252, v252, 7, v240
    buffer_load_dwordx4 v252, s[28:31], 0 offen lds
    s_add_u32 m0, s73, 50176
    v_lshl_add_u32 v254, v254, 7, v241
    buffer_load_dwordx4 v254, s[28:31], 0 offen lds
    s_add_u32 m0, s73, 51200
    v_lshl_add_u32 v192, v192, 7, v240
    buffer_load_dwordx4 v192, s[28:31], 0 offen lds
    s_add_u32 m0, s73, 52224
    v_lshl_add_u32 v194, v194, 7, v241
    buffer_load_dwordx4 v194, s[28:31], 0 offen lds
    s_add_u32 m0, s75, 49152
    s_add_u32 s70, s100, 65536
    buffer_load_dwordx4 v236, s[32:35], s70 offen lds
    s_add_u32 m0, s75, 50176
    s_add_u32 s70, s100, 67584
    buffer_load_dwordx4 v236, s[32:35], s70 offen lds
    s_add_u32 m0, s75, 51200
    s_add_u32 s70, s100, 69632
    buffer_load_dwordx4 v237, s[32:35], s70 offen lds
    s_add_u32 m0, s75, 52224
    s_add_u32 s70, s100, 71680
    buffer_load_dwordx4 v237, s[32:35], s70 offen lds
    v_lshl_add_u32 v228, v228, 7, v242
    v_lshl_add_u32 v229, v229, 7, v242
    buffer_load_dwordx4 v[232:235], v229, s[28:31], 0 offen
    buffer_load_dwordx4 v[228:231], v228, s[28:31], 0 offen
    v_lshl_add_u32 v0, v0, 7, v242
    v_lshl_add_u32 v1, v1, 7, v242
    buffer_load_dwordx4 v[4:7], v1, s[28:31], 0 offen
    buffer_load_dwordx4 v[0:3], v0, s[28:31], 0 offen
    s_waitcnt vmcnt(20)
    s_barrier
    s_add_u32 m0, s73, 0
    v_lshl_add_u32 v244, v244, 7, v240
    buffer_load_dwordx4 v244, s[28:31], 0 offen lds
    s_add_u32 m0, s73, 1024
    v_lshl_add_u32 v246, v246, 7, v241
    buffer_load_dwordx4 v246, s[28:31], 0 offen lds
    s_add_u32 m0, s73, 2048
    v_lshl_add_u32 v248, v248, 7, v240
    buffer_load_dwordx4 v248, s[28:31], 0 offen lds
    s_add_u32 m0, s73, 3072
    v_lshl_add_u32 v250, v250, 7, v241
    buffer_load_dwordx4 v250, s[28:31], 0 offen lds
    s_add_u32 m0, s75, 0
    s_add_u32 s70, s101, 98304
    buffer_load_dwordx4 v236, s[32:35], s70 offen lds
    s_add_u32 m0, s75, 1024
    s_add_u32 s70, s101, 100352
    buffer_load_dwordx4 v236, s[32:35], s70 offen lds
    s_add_u32 m0, s75, 2048
    s_add_u32 s70, s101, 102400
    buffer_load_dwordx4 v237, s[32:35], s70 offen lds
    s_add_u32 m0, s75, 3072
    s_add_u32 s70, s101, 104448
    buffer_load_dwordx4 v237, s[32:35], s70 offen lds
    v_lshl_add_u32 v48, v48, 7, v242
    v_lshl_add_u32 v49, v49, 7, v242
    buffer_load_dwordx4 v[52:55], v49, s[28:31], 0 offen
    buffer_load_dwordx4 v[48:51], v48, s[28:31], 0 offen
    v_lshl_add_u32 v96, v96, 7, v242
    v_lshl_add_u32 v97, v97, 7, v242
    buffer_load_dwordx4 v[100:103], v97, s[28:31], 0 offen
    buffer_load_dwordx4 v[96:99], v96, s[28:31], 0 offen
    s_waitcnt vmcnt(24)
    s_barrier
    s_add_u32 m0, s73, 16384
    v_lshl_add_u32 v253, v253, 7, v240
    buffer_load_dwordx4 v253, s[28:31], 0 offen lds
    s_add_u32 m0, s73, 17408
    v_lshl_add_u32 v255, v255, 7, v241
    buffer_load_dwordx4 v255, s[28:31], 0 offen lds
    s_add_u32 m0, s73, 18432
    v_lshl_add_u32 v193, v193, 7, v240
    buffer_load_dwordx4 v193, s[28:31], 0 offen lds
    s_add_u32 m0, s73, 19456
    v_lshl_add_u32 v195, v195, 7, v241
    buffer_load_dwordx4 v195, s[28:31], 0 offen lds
    s_add_u32 m0, s75, 16384
    s_add_u32 s70, s100, 131072
    buffer_load_dwordx4 v236, s[32:35], s70 offen lds
    s_add_u32 m0, s75, 17408
    s_add_u32 s70, s100, 133120
    buffer_load_dwordx4 v236, s[32:35], s70 offen lds
    s_add_u32 m0, s75, 18432
    s_add_u32 s70, s100, 135168
    buffer_load_dwordx4 v237, s[32:35], s70 offen lds
    s_add_u32 m0, s75, 19456
    s_add_u32 s70, s100, 137216
    buffer_load_dwordx4 v237, s[32:35], s70 offen lds
    v_lshl_add_u32 v144, v144, 7, v242
    v_lshl_add_u32 v145, v145, 7, v242
    buffer_load_dwordx4 v[148:151], v145, s[28:31], 0 offen
    buffer_load_dwordx4 v[144:147], v144, s[28:31], 0 offen
    v_lshl_add_u32 v8, v8, 7, v242
    v_lshl_add_u32 v9, v9, 7, v242
    buffer_load_dwordx4 v[12:15], v9, s[28:31], 0 offen
    buffer_load_dwordx4 v[8:11], v8, s[28:31], 0 offen
    s_waitcnt vmcnt(28)
    s_barrier
    s_add_u32 m0, s73, 32768
    v_lshl_add_u32 v245, v245, 7, v240
    buffer_load_dwordx4 v245, s[28:31], 0 offen lds
    s_add_u32 m0, s73, 33792
    v_lshl_add_u32 v247, v247, 7, v241
    buffer_load_dwordx4 v247, s[28:31], 0 offen lds
    s_add_u32 m0, s73, 34816
    v_lshl_add_u32 v249, v249, 7, v240
    buffer_load_dwordx4 v249, s[28:31], 0 offen lds
    s_add_u32 m0, s73, 35840
    v_lshl_add_u32 v251, v251, 7, v241
    buffer_load_dwordx4 v251, s[28:31], 0 offen lds
    s_waitcnt vmcnt(30)
    s_mov_b64 vcc, s[48:49]
    v_cndmask_b32_dpp v220, v232, v228, vcc quad_perm:[1,0,3,2] row_mask:0xf bank_mask:0xf
    v_cndmask_b32_dpp v221, v233, v229, vcc quad_perm:[1,0,3,2] row_mask:0xf bank_mask:0xf
    v_cndmask_b32_dpp v222, v234, v230, vcc quad_perm:[1,0,3,2] row_mask:0xf bank_mask:0xf
    v_cndmask_b32_dpp v223, v235, v231, vcc quad_perm:[1,0,3,2] row_mask:0xf bank_mask:0xf
    s_mov_b64 vcc, s[50:51]
    v_cndmask_b32_dpp v224, v228, v232, vcc quad_perm:[1,0,3,2] row_mask:0xf bank_mask:0xf
    v_cndmask_b32_dpp v225, v229, v233, vcc quad_perm:[1,0,3,2] row_mask:0xf bank_mask:0xf
    v_cndmask_b32_dpp v226, v230, v234, vcc quad_perm:[1,0,3,2] row_mask:0xf bank_mask:0xf
    v_cndmask_b32_dpp v227, v231, v235, vcc quad_perm:[1,0,3,2] row_mask:0xf bank_mask:0xf
    s_add_u32 m0, s75, 32768
    s_add_u32 s70, s101, 163840
    buffer_load_dwordx4 v236, s[32:35], s70 offen lds
    s_add_u32 m0, s75, 33792
    s_add_u32 s70, s101, 165888
    buffer_load_dwordx4 v236, s[32:35], s70 offen lds
    v_permlane32_swap_b32 v220, v222
    v_permlane32_swap_b32 v221, v223
    v_permlane32_swap_b32 v224, v226
    v_permlane32_swap_b32 v225, v227
    s_mov_b64 vcc, s[52:53]
    v_cndmask_b32_dpp v228, v222, v220, vcc quad_perm:[2,3,0,1] row_mask:0xf bank_mask:0xf
    v_cndmask_b32_dpp v229, v223, v221, vcc quad_perm:[2,3,0,1] row_mask:0xf bank_mask:0xf
    v_cndmask_b32_dpp v232, v226, v224, vcc quad_perm:[2,3,0,1] row_mask:0xf bank_mask:0xf
    v_cndmask_b32_dpp v233, v227, v225, vcc quad_perm:[2,3,0,1] row_mask:0xf bank_mask:0xf
    s_add_u32 m0, s75, 34816
    s_add_u32 s70, s101, 167936
    buffer_load_dwordx4 v237, s[32:35], s70 offen lds
    s_add_u32 m0, s75, 35840
    s_add_u32 s70, s101, 169984
    buffer_load_dwordx4 v237, s[32:35], s70 offen lds
    s_mov_b64 vcc, s[54:55]
    v_cndmask_b32_dpp v230, v220, v222, vcc quad_perm:[2,3,0,1] row_mask:0xf bank_mask:0xf
    v_cndmask_b32_dpp v231, v221, v223, vcc quad_perm:[2,3,0,1] row_mask:0xf bank_mask:0xf
    v_cndmask_b32_dpp v234, v224, v226, vcc quad_perm:[2,3,0,1] row_mask:0xf bank_mask:0xf
    v_cndmask_b32_dpp v235, v225, v227, vcc quad_perm:[2,3,0,1] row_mask:0xf bank_mask:0xf
    v_lshl_add_u32 v56, v56, 7, v242
    v_lshl_add_u32 v57, v57, 7, v242
    buffer_load_dwordx4 v[60:63], v57, s[28:31], 0 offen
    buffer_load_dwordx4 v[56:59], v56, s[28:31], 0 offen
    v_lshl_add_u32 v104, v104, 7, v242
    v_lshl_add_u32 v105, v105, 7, v242
    buffer_load_dwordx4 v[108:111], v105, s[28:31], 0 offen
    buffer_load_dwordx4 v[104:107], v104, s[28:31], 0 offen
    s_waitcnt vmcnt(28)
    s_barrier
    s_add_u32 m0, s73, 49152
    v_lshl_add_u32 v142, v142, 7, v240
    buffer_load_dwordx4 v142, s[28:31], 0 offen lds
    s_add_u32 m0, s73, 50176
    v_lshl_add_u32 v186, v186, 7, v241
    buffer_load_dwordx4 v186, s[28:31], 0 offen lds
    s_add_u32 m0, s73, 51200
    v_lshl_add_u32 v188, v188, 7, v240
    buffer_load_dwordx4 v188, s[28:31], 0 offen lds
    s_add_u32 m0, s73, 52224
    v_lshl_add_u32 v190, v190, 7, v241
    buffer_load_dwordx4 v190, s[28:31], 0 offen lds
    s_mov_b64 vcc, s[48:49]
    v_cndmask_b32_dpp v220, v4, v0, vcc quad_perm:[1,0,3,2] row_mask:0xf bank_mask:0xf
    v_cndmask_b32_dpp v221, v5, v1, vcc quad_perm:[1,0,3,2] row_mask:0xf bank_mask:0xf
    v_cndmask_b32_dpp v222, v6, v2, vcc quad_perm:[1,0,3,2] row_mask:0xf bank_mask:0xf
    v_cndmask_b32_dpp v223, v7, v3, vcc quad_perm:[1,0,3,2] row_mask:0xf bank_mask:0xf
    s_mov_b64 vcc, s[50:51]
    v_cndmask_b32_dpp v224, v0, v4, vcc quad_perm:[1,0,3,2] row_mask:0xf bank_mask:0xf
    v_cndmask_b32_dpp v225, v1, v5, vcc quad_perm:[1,0,3,2] row_mask:0xf bank_mask:0xf
    v_cndmask_b32_dpp v226, v2, v6, vcc quad_perm:[1,0,3,2] row_mask:0xf bank_mask:0xf
    v_cndmask_b32_dpp v227, v3, v7, vcc quad_perm:[1,0,3,2] row_mask:0xf bank_mask:0xf
    s_add_u32 m0, s75, 49152
    s_add_u32 s70, s100, 196608
    buffer_load_dwordx4 v236, s[32:35], s70 offen lds
    s_add_u32 m0, s75, 50176
    s_add_u32 s70, s100, 198656
    buffer_load_dwordx4 v236, s[32:35], s70 offen lds
    v_permlane32_swap_b32 v220, v222
    v_permlane32_swap_b32 v221, v223
    v_permlane32_swap_b32 v224, v226
    v_permlane32_swap_b32 v225, v227
    s_mov_b64 vcc, s[52:53]
    v_cndmask_b32_dpp v0, v222, v220, vcc quad_perm:[2,3,0,1] row_mask:0xf bank_mask:0xf
    v_cndmask_b32_dpp v1, v223, v221, vcc quad_perm:[2,3,0,1] row_mask:0xf bank_mask:0xf
    v_cndmask_b32_dpp v4, v226, v224, vcc quad_perm:[2,3,0,1] row_mask:0xf bank_mask:0xf
    v_cndmask_b32_dpp v5, v227, v225, vcc quad_perm:[2,3,0,1] row_mask:0xf bank_mask:0xf
    s_add_u32 m0, s75, 51200
    s_add_u32 s70, s100, 200704
    buffer_load_dwordx4 v237, s[32:35], s70 offen lds
    s_add_u32 m0, s75, 52224
    s_add_u32 s70, s100, 202752
    buffer_load_dwordx4 v237, s[32:35], s70 offen lds
    s_mov_b64 vcc, s[54:55]
    v_cndmask_b32_dpp v2, v220, v222, vcc quad_perm:[2,3,0,1] row_mask:0xf bank_mask:0xf
    v_cndmask_b32_dpp v3, v221, v223, vcc quad_perm:[2,3,0,1] row_mask:0xf bank_mask:0xf
    v_cndmask_b32_dpp v6, v224, v226, vcc quad_perm:[2,3,0,1] row_mask:0xf bank_mask:0xf
    v_cndmask_b32_dpp v7, v225, v227, vcc quad_perm:[2,3,0,1] row_mask:0xf bank_mask:0xf
    v_lshl_add_u32 v152, v152, 7, v242
    v_lshl_add_u32 v153, v153, 7, v242
    buffer_load_dwordx4 v[156:159], v153, s[28:31], 0 offen
    buffer_load_dwordx4 v[152:155], v152, s[28:31], 0 offen
    v_lshl_add_u32 v16, v16, 7, v242
    v_lshl_add_u32 v17, v17, 7, v242
    buffer_load_dwordx4 v[20:23], v17, s[28:31], 0 offen
    buffer_load_dwordx4 v[16:19], v16, s[28:31], 0 offen
    s_waitcnt vmcnt(28)
    s_barrier
    s_add_u32 m0, s73, 0
    v_lshl_add_u32 v92, v92, 7, v240
    buffer_load_dwordx4 v92, s[28:31], 0 offen lds
    s_add_u32 m0, s73, 1024
    v_lshl_add_u32 v94, v94, 7, v241
    buffer_load_dwordx4 v94, s[28:31], 0 offen lds
    s_add_u32 m0, s73, 2048
    v_lshl_add_u32 v138, v138, 7, v240
    buffer_load_dwordx4 v138, s[28:31], 0 offen lds
    s_add_u32 m0, s73, 3072
    v_lshl_add_u32 v140, v140, 7, v241
    buffer_load_dwordx4 v140, s[28:31], 0 offen lds
    s_mov_b64 vcc, s[48:49]
    v_cndmask_b32_dpp v220, v52, v48, vcc quad_perm:[1,0,3,2] row_mask:0xf bank_mask:0xf
    v_cndmask_b32_dpp v221, v53, v49, vcc quad_perm:[1,0,3,2] row_mask:0xf bank_mask:0xf
    v_cndmask_b32_dpp v222, v54, v50, vcc quad_perm:[1,0,3,2] row_mask:0xf bank_mask:0xf
    v_cndmask_b32_dpp v223, v55, v51, vcc quad_perm:[1,0,3,2] row_mask:0xf bank_mask:0xf
    s_mov_b64 vcc, s[50:51]
    v_cndmask_b32_dpp v224, v48, v52, vcc quad_perm:[1,0,3,2] row_mask:0xf bank_mask:0xf
    v_cndmask_b32_dpp v225, v49, v53, vcc quad_perm:[1,0,3,2] row_mask:0xf bank_mask:0xf
    v_cndmask_b32_dpp v226, v50, v54, vcc quad_perm:[1,0,3,2] row_mask:0xf bank_mask:0xf
    v_cndmask_b32_dpp v227, v51, v55, vcc quad_perm:[1,0,3,2] row_mask:0xf bank_mask:0xf
    s_add_u32 m0, s75, 0
    s_add_u32 s70, s101, 229376
    buffer_load_dwordx4 v236, s[32:35], s70 offen lds
    s_add_u32 m0, s75, 1024
    s_add_u32 s70, s101, 231424
    buffer_load_dwordx4 v236, s[32:35], s70 offen lds
    v_permlane32_swap_b32 v220, v222
    v_permlane32_swap_b32 v221, v223
    v_permlane32_swap_b32 v224, v226
    v_permlane32_swap_b32 v225, v227
    s_mov_b64 vcc, s[52:53]
    v_cndmask_b32_dpp v48, v222, v220, vcc quad_perm:[2,3,0,1] row_mask:0xf bank_mask:0xf
    v_cndmask_b32_dpp v49, v223, v221, vcc quad_perm:[2,3,0,1] row_mask:0xf bank_mask:0xf
    v_cndmask_b32_dpp v52, v226, v224, vcc quad_perm:[2,3,0,1] row_mask:0xf bank_mask:0xf
    v_cndmask_b32_dpp v53, v227, v225, vcc quad_perm:[2,3,0,1] row_mask:0xf bank_mask:0xf
    s_add_u32 m0, s75, 2048
    s_add_u32 s70, s101, 233472
    buffer_load_dwordx4 v237, s[32:35], s70 offen lds
    s_add_u32 m0, s75, 3072
    s_add_u32 s70, s101, 235520
    buffer_load_dwordx4 v237, s[32:35], s70 offen lds
    s_mov_b64 vcc, s[54:55]
    v_cndmask_b32_dpp v50, v220, v222, vcc quad_perm:[2,3,0,1] row_mask:0xf bank_mask:0xf
    v_cndmask_b32_dpp v51, v221, v223, vcc quad_perm:[2,3,0,1] row_mask:0xf bank_mask:0xf
    v_cndmask_b32_dpp v54, v224, v226, vcc quad_perm:[2,3,0,1] row_mask:0xf bank_mask:0xf
    v_cndmask_b32_dpp v55, v225, v227, vcc quad_perm:[2,3,0,1] row_mask:0xf bank_mask:0xf
    v_lshl_add_u32 v64, v64, 7, v242
    v_lshl_add_u32 v65, v65, 7, v242
    buffer_load_dwordx4 v[68:71], v65, s[28:31], 0 offen
    buffer_load_dwordx4 v[64:67], v64, s[28:31], 0 offen
    v_lshl_add_u32 v112, v112, 7, v242
    v_lshl_add_u32 v113, v113, 7, v242
    buffer_load_dwordx4 v[116:119], v113, s[28:31], 0 offen
    buffer_load_dwordx4 v[112:115], v112, s[28:31], 0 offen
    s_waitcnt vmcnt(28)
    s_barrier
    s_add_u32 m0, s73, 16384
    v_lshl_add_u32 v143, v143, 7, v240
    buffer_load_dwordx4 v143, s[28:31], 0 offen lds
    s_add_u32 m0, s73, 17408
    v_lshl_add_u32 v187, v187, 7, v241
    buffer_load_dwordx4 v187, s[28:31], 0 offen lds
    s_add_u32 m0, s73, 18432
    v_lshl_add_u32 v189, v189, 7, v240
    buffer_load_dwordx4 v189, s[28:31], 0 offen lds
    s_add_u32 m0, s73, 19456
    v_lshl_add_u32 v191, v191, 7, v241
    buffer_load_dwordx4 v191, s[28:31], 0 offen lds
    s_mov_b64 vcc, s[48:49]
    v_cndmask_b32_dpp v220, v100, v96, vcc quad_perm:[1,0,3,2] row_mask:0xf bank_mask:0xf
    v_cndmask_b32_dpp v221, v101, v97, vcc quad_perm:[1,0,3,2] row_mask:0xf bank_mask:0xf
    v_cndmask_b32_dpp v222, v102, v98, vcc quad_perm:[1,0,3,2] row_mask:0xf bank_mask:0xf
    v_cndmask_b32_dpp v223, v103, v99, vcc quad_perm:[1,0,3,2] row_mask:0xf bank_mask:0xf
    s_mov_b64 vcc, s[50:51]
    v_cndmask_b32_dpp v224, v96, v100, vcc quad_perm:[1,0,3,2] row_mask:0xf bank_mask:0xf
    v_cndmask_b32_dpp v225, v97, v101, vcc quad_perm:[1,0,3,2] row_mask:0xf bank_mask:0xf
    v_cndmask_b32_dpp v226, v98, v102, vcc quad_perm:[1,0,3,2] row_mask:0xf bank_mask:0xf
    v_cndmask_b32_dpp v227, v99, v103, vcc quad_perm:[1,0,3,2] row_mask:0xf bank_mask:0xf
    s_add_u32 m0, s75, 16384
    s_add_u32 s70, s100, 262144
    buffer_load_dwordx4 v236, s[32:35], s70 offen lds
    v_permlane32_swap_b32 v220, v222
    v_permlane32_swap_b32 v221, v223
    v_permlane32_swap_b32 v224, v226
    v_permlane32_swap_b32 v225, v227
    s_mov_b64 vcc, s[52:53]
    v_cndmask_b32_dpp v96, v222, v220, vcc quad_perm:[2,3,0,1] row_mask:0xf bank_mask:0xf
    v_cndmask_b32_dpp v97, v223, v221, vcc quad_perm:[2,3,0,1] row_mask:0xf bank_mask:0xf
    v_cndmask_b32_dpp v100, v226, v224, vcc quad_perm:[2,3,0,1] row_mask:0xf bank_mask:0xf
    v_cndmask_b32_dpp v101, v227, v225, vcc quad_perm:[2,3,0,1] row_mask:0xf bank_mask:0xf
    s_add_u32 m0, s75, 17408
    s_add_u32 s70, s100, 264192
    buffer_load_dwordx4 v236, s[32:35], s70 offen lds
    s_add_u32 m0, s75, 18432
    s_add_u32 s70, s100, 266240
    buffer_load_dwordx4 v237, s[32:35], s70 offen lds
    s_mov_b64 vcc, s[54:55]
    v_cndmask_b32_dpp v98, v220, v222, vcc quad_perm:[2,3,0,1] row_mask:0xf bank_mask:0xf
    v_cndmask_b32_dpp v99, v221, v223, vcc quad_perm:[2,3,0,1] row_mask:0xf bank_mask:0xf
    v_cndmask_b32_dpp v102, v224, v226, vcc quad_perm:[2,3,0,1] row_mask:0xf bank_mask:0xf
    v_cndmask_b32_dpp v103, v225, v227, vcc quad_perm:[2,3,0,1] row_mask:0xf bank_mask:0xf
    s_add_u32 m0, s75, 19456
    s_add_u32 s70, s100, 268288
    buffer_load_dwordx4 v237, s[32:35], s70 offen lds
    v_lshl_add_u32 v160, v160, 7, v242
    v_lshl_add_u32 v161, v161, 7, v242
    buffer_load_dwordx4 v[164:167], v161, s[28:31], 0 offen
    buffer_load_dwordx4 v[160:163], v160, s[28:31], 0 offen
    s_waitcnt vmcnt(26)
    s_barrier
    s_add_u32 m0, s73, 32768
    v_lshl_add_u32 v93, v93, 7, v240
    buffer_load_dwordx4 v93, s[28:31], 0 offen lds
    s_add_u32 m0, s73, 33792
    v_lshl_add_u32 v95, v95, 7, v241
    buffer_load_dwordx4 v95, s[28:31], 0 offen lds
    s_add_u32 m0, s73, 34816
    v_lshl_add_u32 v139, v139, 7, v240
    buffer_load_dwordx4 v139, s[28:31], 0 offen lds
    s_add_u32 m0, s73, 35840
    v_lshl_add_u32 v141, v141, 7, v241
    buffer_load_dwordx4 v141, s[28:31], 0 offen lds
    s_mov_b64 vcc, s[48:49]
    v_cndmask_b32_dpp v220, v148, v144, vcc quad_perm:[1,0,3,2] row_mask:0xf bank_mask:0xf
    v_cndmask_b32_dpp v221, v149, v145, vcc quad_perm:[1,0,3,2] row_mask:0xf bank_mask:0xf
    v_cndmask_b32_dpp v222, v150, v146, vcc quad_perm:[1,0,3,2] row_mask:0xf bank_mask:0xf
    v_cndmask_b32_dpp v223, v151, v147, vcc quad_perm:[1,0,3,2] row_mask:0xf bank_mask:0xf
    s_mov_b64 vcc, s[50:51]
    v_cndmask_b32_dpp v224, v144, v148, vcc quad_perm:[1,0,3,2] row_mask:0xf bank_mask:0xf
    v_cndmask_b32_dpp v225, v145, v149, vcc quad_perm:[1,0,3,2] row_mask:0xf bank_mask:0xf
    v_cndmask_b32_dpp v226, v146, v150, vcc quad_perm:[1,0,3,2] row_mask:0xf bank_mask:0xf
    v_cndmask_b32_dpp v227, v147, v151, vcc quad_perm:[1,0,3,2] row_mask:0xf bank_mask:0xf
    s_add_u32 m0, s75, 32768
    s_add_u32 s70, s101, 294912
    buffer_load_dwordx4 v236, s[32:35], s70 offen lds
    v_permlane32_swap_b32 v220, v222
    v_permlane32_swap_b32 v221, v223
    v_permlane32_swap_b32 v224, v226
    v_permlane32_swap_b32 v225, v227
    s_mov_b64 vcc, s[52:53]
    v_cndmask_b32_dpp v144, v222, v220, vcc quad_perm:[2,3,0,1] row_mask:0xf bank_mask:0xf
    v_cndmask_b32_dpp v145, v223, v221, vcc quad_perm:[2,3,0,1] row_mask:0xf bank_mask:0xf
    v_cndmask_b32_dpp v148, v226, v224, vcc quad_perm:[2,3,0,1] row_mask:0xf bank_mask:0xf
    v_cndmask_b32_dpp v149, v227, v225, vcc quad_perm:[2,3,0,1] row_mask:0xf bank_mask:0xf
    s_add_u32 m0, s75, 33792
    s_add_u32 s70, s101, 296960
    buffer_load_dwordx4 v236, s[32:35], s70 offen lds
    s_mov_b64 vcc, s[54:55]
    v_cndmask_b32_dpp v146, v220, v222, vcc quad_perm:[2,3,0,1] row_mask:0xf bank_mask:0xf
    v_cndmask_b32_dpp v147, v221, v223, vcc quad_perm:[2,3,0,1] row_mask:0xf bank_mask:0xf
    v_cndmask_b32_dpp v150, v224, v226, vcc quad_perm:[2,3,0,1] row_mask:0xf bank_mask:0xf
    v_cndmask_b32_dpp v151, v225, v227, vcc quad_perm:[2,3,0,1] row_mask:0xf bank_mask:0xf
    s_add_u32 m0, s75, 34816
    s_add_u32 s70, s101, 299008
    buffer_load_dwordx4 v237, s[32:35], s70 offen lds
    s_add_u32 m0, s75, 35840
    s_add_u32 s70, s101, 301056
    buffer_load_dwordx4 v237, s[32:35], s70 offen lds
    s_waitcnt vmcnt(22)
    s_barrier
    s_add_u32 m0, s73, 49152
    v_lshl_add_u32 v42, v42, 7, v240
    buffer_load_dwordx4 v42, s[28:31], 0 offen lds
    s_add_u32 m0, s73, 50176
    v_lshl_add_u32 v44, v44, 7, v241
    buffer_load_dwordx4 v44, s[28:31], 0 offen lds
    s_add_u32 m0, s73, 51200
    v_lshl_add_u32 v46, v46, 7, v240
    buffer_load_dwordx4 v46, s[28:31], 0 offen lds
    s_add_u32 m0, s73, 52224
    v_lshl_add_u32 v90, v90, 7, v241
    buffer_load_dwordx4 v90, s[28:31], 0 offen lds
    s_mov_b64 vcc, s[48:49]
    v_cndmask_b32_dpp v220, v12, v8, vcc quad_perm:[1,0,3,2] row_mask:0xf bank_mask:0xf
    v_cndmask_b32_dpp v221, v13, v9, vcc quad_perm:[1,0,3,2] row_mask:0xf bank_mask:0xf
    v_cndmask_b32_dpp v222, v14, v10, vcc quad_perm:[1,0,3,2] row_mask:0xf bank_mask:0xf
    v_cndmask_b32_dpp v223, v15, v11, vcc quad_perm:[1,0,3,2] row_mask:0xf bank_mask:0xf
    s_mov_b64 vcc, s[50:51]
    v_cndmask_b32_dpp v224, v8, v12, vcc quad_perm:[1,0,3,2] row_mask:0xf bank_mask:0xf
    v_cndmask_b32_dpp v225, v9, v13, vcc quad_perm:[1,0,3,2] row_mask:0xf bank_mask:0xf
    v_cndmask_b32_dpp v226, v10, v14, vcc quad_perm:[1,0,3,2] row_mask:0xf bank_mask:0xf
    v_cndmask_b32_dpp v227, v11, v15, vcc quad_perm:[1,0,3,2] row_mask:0xf bank_mask:0xf
    s_add_u32 m0, s75, 49152
    s_add_u32 s70, s100, 327680
    buffer_load_dwordx4 v236, s[32:35], s70 offen lds
    v_permlane32_swap_b32 v220, v222
    v_permlane32_swap_b32 v221, v223
    v_permlane32_swap_b32 v224, v226
    v_permlane32_swap_b32 v225, v227
    s_mov_b64 vcc, s[52:53]
    v_cndmask_b32_dpp v8, v222, v220, vcc quad_perm:[2,3,0,1] row_mask:0xf bank_mask:0xf
    v_cndmask_b32_dpp v9, v223, v221, vcc quad_perm:[2,3,0,1] row_mask:0xf bank_mask:0xf
    v_cndmask_b32_dpp v12, v226, v224, vcc quad_perm:[2,3,0,1] row_mask:0xf bank_mask:0xf
    v_cndmask_b32_dpp v13, v227, v225, vcc quad_perm:[2,3,0,1] row_mask:0xf bank_mask:0xf
    s_add_u32 m0, s75, 50176
    s_add_u32 s70, s100, 329728
    buffer_load_dwordx4 v236, s[32:35], s70 offen lds
    s_mov_b64 vcc, s[54:55]
    v_cndmask_b32_dpp v10, v220, v222, vcc quad_perm:[2,3,0,1] row_mask:0xf bank_mask:0xf
    v_cndmask_b32_dpp v11, v221, v223, vcc quad_perm:[2,3,0,1] row_mask:0xf bank_mask:0xf
    v_cndmask_b32_dpp v14, v224, v226, vcc quad_perm:[2,3,0,1] row_mask:0xf bank_mask:0xf
    v_cndmask_b32_dpp v15, v225, v227, vcc quad_perm:[2,3,0,1] row_mask:0xf bank_mask:0xf
    s_add_u32 m0, s75, 51200
    s_add_u32 s70, s100, 331776
    buffer_load_dwordx4 v237, s[32:35], s70 offen lds
    s_add_u32 m0, s75, 52224
    s_add_u32 s70, s100, 333824
    buffer_load_dwordx4 v237, s[32:35], s70 offen lds
    s_waitcnt vmcnt(18)
    s_barrier
    s_add_u32 m0, s73, 0
    v_lshl_add_u32 v134, v134, 7, v240
    buffer_load_dwordx4 v134, s[28:31], 0 offen lds
    s_add_u32 m0, s73, 1024
    v_lshl_add_u32 v178, v178, 7, v241
    buffer_load_dwordx4 v178, s[28:31], 0 offen lds
    s_add_u32 m0, s73, 2048
    v_lshl_add_u32 v180, v180, 7, v240
    buffer_load_dwordx4 v180, s[28:31], 0 offen lds
    s_add_u32 m0, s73, 3072
    v_lshl_add_u32 v182, v182, 7, v241
    buffer_load_dwordx4 v182, s[28:31], 0 offen lds
    s_mov_b64 vcc, s[48:49]
    v_cndmask_b32_dpp v220, v60, v56, vcc quad_perm:[1,0,3,2] row_mask:0xf bank_mask:0xf
    v_cndmask_b32_dpp v221, v61, v57, vcc quad_perm:[1,0,3,2] row_mask:0xf bank_mask:0xf
    v_cndmask_b32_dpp v222, v62, v58, vcc quad_perm:[1,0,3,2] row_mask:0xf bank_mask:0xf
    v_cndmask_b32_dpp v223, v63, v59, vcc quad_perm:[1,0,3,2] row_mask:0xf bank_mask:0xf
    s_mov_b64 vcc, s[50:51]
    v_cndmask_b32_dpp v224, v56, v60, vcc quad_perm:[1,0,3,2] row_mask:0xf bank_mask:0xf
    v_cndmask_b32_dpp v225, v57, v61, vcc quad_perm:[1,0,3,2] row_mask:0xf bank_mask:0xf
    v_cndmask_b32_dpp v226, v58, v62, vcc quad_perm:[1,0,3,2] row_mask:0xf bank_mask:0xf
    v_cndmask_b32_dpp v227, v59, v63, vcc quad_perm:[1,0,3,2] row_mask:0xf bank_mask:0xf
    s_add_u32 m0, s75, 0
    s_add_u32 s70, s101, 360448
    buffer_load_dwordx4 v236, s[32:35], s70 offen lds
    v_permlane32_swap_b32 v220, v222
    v_permlane32_swap_b32 v221, v223
    v_permlane32_swap_b32 v224, v226
    v_permlane32_swap_b32 v225, v227
    s_mov_b64 vcc, s[52:53]
    v_cndmask_b32_dpp v56, v222, v220, vcc quad_perm:[2,3,0,1] row_mask:0xf bank_mask:0xf
    v_cndmask_b32_dpp v57, v223, v221, vcc quad_perm:[2,3,0,1] row_mask:0xf bank_mask:0xf
    v_cndmask_b32_dpp v60, v226, v224, vcc quad_perm:[2,3,0,1] row_mask:0xf bank_mask:0xf
    v_cndmask_b32_dpp v61, v227, v225, vcc quad_perm:[2,3,0,1] row_mask:0xf bank_mask:0xf
    s_add_u32 m0, s75, 1024
    s_add_u32 s70, s101, 362496
    buffer_load_dwordx4 v236, s[32:35], s70 offen lds
    s_mov_b64 vcc, s[54:55]
    v_cndmask_b32_dpp v58, v220, v222, vcc quad_perm:[2,3,0,1] row_mask:0xf bank_mask:0xf
    v_cndmask_b32_dpp v59, v221, v223, vcc quad_perm:[2,3,0,1] row_mask:0xf bank_mask:0xf
    v_cndmask_b32_dpp v62, v224, v226, vcc quad_perm:[2,3,0,1] row_mask:0xf bank_mask:0xf
    v_cndmask_b32_dpp v63, v225, v227, vcc quad_perm:[2,3,0,1] row_mask:0xf bank_mask:0xf
    s_add_u32 m0, s75, 2048
    s_add_u32 s70, s101, 364544
    buffer_load_dwordx4 v237, s[32:35], s70 offen lds
    s_add_u32 m0, s75, 3072
    s_add_u32 s70, s101, 366592
    buffer_load_dwordx4 v237, s[32:35], s70 offen lds
    s_waitcnt vmcnt(16)
    s_barrier
    s_add_u32 m0, s73, 16384
    v_lshl_add_u32 v43, v43, 7, v240
    buffer_load_dwordx4 v43, s[28:31], 0 offen lds
    s_add_u32 m0, s73, 17408
    v_lshl_add_u32 v45, v45, 7, v241
    buffer_load_dwordx4 v45, s[28:31], 0 offen lds
    s_add_u32 m0, s73, 18432
    v_lshl_add_u32 v47, v47, 7, v240
    buffer_load_dwordx4 v47, s[28:31], 0 offen lds
    s_add_u32 m0, s73, 19456
    v_lshl_add_u32 v91, v91, 7, v241
    buffer_load_dwordx4 v91, s[28:31], 0 offen lds
    s_mov_b64 vcc, s[48:49]
    v_cndmask_b32_dpp v220, v108, v104, vcc quad_perm:[1,0,3,2] row_mask:0xf bank_mask:0xf
    v_cndmask_b32_dpp v221, v109, v105, vcc quad_perm:[1,0,3,2] row_mask:0xf bank_mask:0xf
    v_cndmask_b32_dpp v222, v110, v106, vcc quad_perm:[1,0,3,2] row_mask:0xf bank_mask:0xf
    v_cndmask_b32_dpp v223, v111, v107, vcc quad_perm:[1,0,3,2] row_mask:0xf bank_mask:0xf
    s_mov_b64 vcc, s[50:51]
    v_cndmask_b32_dpp v224, v104, v108, vcc quad_perm:[1,0,3,2] row_mask:0xf bank_mask:0xf
    v_cndmask_b32_dpp v225, v105, v109, vcc quad_perm:[1,0,3,2] row_mask:0xf bank_mask:0xf
    v_cndmask_b32_dpp v226, v106, v110, vcc quad_perm:[1,0,3,2] row_mask:0xf bank_mask:0xf
    v_cndmask_b32_dpp v227, v107, v111, vcc quad_perm:[1,0,3,2] row_mask:0xf bank_mask:0xf
    s_add_u32 m0, s75, 16384
    s_add_u32 s70, s100, 393216
    buffer_load_dwordx4 v236, s[32:35], s70 offen lds
    v_permlane32_swap_b32 v220, v222
    v_permlane32_swap_b32 v221, v223
    v_permlane32_swap_b32 v224, v226
    v_permlane32_swap_b32 v225, v227
    s_mov_b64 vcc, s[52:53]
    v_cndmask_b32_dpp v104, v222, v220, vcc quad_perm:[2,3,0,1] row_mask:0xf bank_mask:0xf
    v_cndmask_b32_dpp v105, v223, v221, vcc quad_perm:[2,3,0,1] row_mask:0xf bank_mask:0xf
    v_cndmask_b32_dpp v108, v226, v224, vcc quad_perm:[2,3,0,1] row_mask:0xf bank_mask:0xf
    v_cndmask_b32_dpp v109, v227, v225, vcc quad_perm:[2,3,0,1] row_mask:0xf bank_mask:0xf
    s_add_u32 m0, s75, 17408
    s_add_u32 s70, s100, 395264
    buffer_load_dwordx4 v236, s[32:35], s70 offen lds
    s_mov_b64 vcc, s[54:55]
    v_cndmask_b32_dpp v106, v220, v222, vcc quad_perm:[2,3,0,1] row_mask:0xf bank_mask:0xf
    v_cndmask_b32_dpp v107, v221, v223, vcc quad_perm:[2,3,0,1] row_mask:0xf bank_mask:0xf
    v_cndmask_b32_dpp v110, v224, v226, vcc quad_perm:[2,3,0,1] row_mask:0xf bank_mask:0xf
    v_cndmask_b32_dpp v111, v225, v227, vcc quad_perm:[2,3,0,1] row_mask:0xf bank_mask:0xf
    s_add_u32 m0, s75, 18432
    s_add_u32 s70, s100, 397312
    buffer_load_dwordx4 v237, s[32:35], s70 offen lds
    s_add_u32 m0, s75, 19456
    s_add_u32 s70, s100, 399360
    buffer_load_dwordx4 v237, s[32:35], s70 offen lds
    s_waitcnt vmcnt(16)
    s_barrier
    s_add_u32 m0, s73, 32768
    v_lshl_add_u32 v135, v135, 7, v240
    buffer_load_dwordx4 v135, s[28:31], 0 offen lds
    s_add_u32 m0, s73, 33792
    v_lshl_add_u32 v179, v179, 7, v241
    buffer_load_dwordx4 v179, s[28:31], 0 offen lds
    s_add_u32 m0, s73, 34816
    v_lshl_add_u32 v181, v181, 7, v240
    buffer_load_dwordx4 v181, s[28:31], 0 offen lds
    s_add_u32 m0, s73, 35840
    v_lshl_add_u32 v183, v183, 7, v241
    buffer_load_dwordx4 v183, s[28:31], 0 offen lds
    s_mov_b64 vcc, s[48:49]
    v_cndmask_b32_dpp v220, v156, v152, vcc quad_perm:[1,0,3,2] row_mask:0xf bank_mask:0xf
    v_cndmask_b32_dpp v221, v157, v153, vcc quad_perm:[1,0,3,2] row_mask:0xf bank_mask:0xf
    v_cndmask_b32_dpp v222, v158, v154, vcc quad_perm:[1,0,3,2] row_mask:0xf bank_mask:0xf
    v_cndmask_b32_dpp v223, v159, v155, vcc quad_perm:[1,0,3,2] row_mask:0xf bank_mask:0xf
    s_mov_b64 vcc, s[50:51]
    v_cndmask_b32_dpp v224, v152, v156, vcc quad_perm:[1,0,3,2] row_mask:0xf bank_mask:0xf
    v_cndmask_b32_dpp v225, v153, v157, vcc quad_perm:[1,0,3,2] row_mask:0xf bank_mask:0xf
    v_cndmask_b32_dpp v226, v154, v158, vcc quad_perm:[1,0,3,2] row_mask:0xf bank_mask:0xf
    v_cndmask_b32_dpp v227, v155, v159, vcc quad_perm:[1,0,3,2] row_mask:0xf bank_mask:0xf
    s_add_u32 m0, s75, 32768
    s_add_u32 s70, s101, 425984
    buffer_load_dwordx4 v236, s[32:35], s70 offen lds
    v_permlane32_swap_b32 v220, v222
    v_permlane32_swap_b32 v221, v223
    v_permlane32_swap_b32 v224, v226
    v_permlane32_swap_b32 v225, v227
    s_mov_b64 vcc, s[52:53]
    v_cndmask_b32_dpp v152, v222, v220, vcc quad_perm:[2,3,0,1] row_mask:0xf bank_mask:0xf
    v_cndmask_b32_dpp v153, v223, v221, vcc quad_perm:[2,3,0,1] row_mask:0xf bank_mask:0xf
    v_cndmask_b32_dpp v156, v226, v224, vcc quad_perm:[2,3,0,1] row_mask:0xf bank_mask:0xf
    v_cndmask_b32_dpp v157, v227, v225, vcc quad_perm:[2,3,0,1] row_mask:0xf bank_mask:0xf
    s_add_u32 m0, s75, 33792
    s_add_u32 s70, s101, 428032
    buffer_load_dwordx4 v236, s[32:35], s70 offen lds
    s_mov_b64 vcc, s[54:55]
    v_cndmask_b32_dpp v154, v220, v222, vcc quad_perm:[2,3,0,1] row_mask:0xf bank_mask:0xf
    v_cndmask_b32_dpp v155, v221, v223, vcc quad_perm:[2,3,0,1] row_mask:0xf bank_mask:0xf
    v_cndmask_b32_dpp v158, v224, v226, vcc quad_perm:[2,3,0,1] row_mask:0xf bank_mask:0xf
    v_cndmask_b32_dpp v159, v225, v227, vcc quad_perm:[2,3,0,1] row_mask:0xf bank_mask:0xf
    s_add_u32 m0, s75, 34816
    s_add_u32 s70, s101, 430080
    buffer_load_dwordx4 v237, s[32:35], s70 offen lds
    s_add_u32 m0, s75, 35840
    s_add_u32 s70, s101, 432128
    buffer_load_dwordx4 v237, s[32:35], s70 offen lds
    s_waitcnt vmcnt(16)
    s_barrier
    s_add_u32 m0, s73, 49152
    v_lshl_add_u32 v84, v84, 7, v240
    buffer_load_dwordx4 v84, s[28:31], 0 offen lds
    s_add_u32 m0, s73, 50176
    v_lshl_add_u32 v86, v86, 7, v241
    buffer_load_dwordx4 v86, s[28:31], 0 offen lds
    s_add_u32 m0, s73, 51200
    v_lshl_add_u32 v130, v130, 7, v240
    buffer_load_dwordx4 v130, s[28:31], 0 offen lds
    s_add_u32 m0, s73, 52224
    v_lshl_add_u32 v132, v132, 7, v241
    buffer_load_dwordx4 v132, s[28:31], 0 offen lds
    s_mov_b64 vcc, s[48:49]
    v_cndmask_b32_dpp v220, v20, v16, vcc quad_perm:[1,0,3,2] row_mask:0xf bank_mask:0xf
    v_cndmask_b32_dpp v221, v21, v17, vcc quad_perm:[1,0,3,2] row_mask:0xf bank_mask:0xf
    v_cndmask_b32_dpp v222, v22, v18, vcc quad_perm:[1,0,3,2] row_mask:0xf bank_mask:0xf
    v_cndmask_b32_dpp v223, v23, v19, vcc quad_perm:[1,0,3,2] row_mask:0xf bank_mask:0xf
    s_mov_b64 vcc, s[50:51]
    v_cndmask_b32_dpp v224, v16, v20, vcc quad_perm:[1,0,3,2] row_mask:0xf bank_mask:0xf
    v_cndmask_b32_dpp v225, v17, v21, vcc quad_perm:[1,0,3,2] row_mask:0xf bank_mask:0xf
    v_cndmask_b32_dpp v226, v18, v22, vcc quad_perm:[1,0,3,2] row_mask:0xf bank_mask:0xf
    v_cndmask_b32_dpp v227, v19, v23, vcc quad_perm:[1,0,3,2] row_mask:0xf bank_mask:0xf
    s_add_u32 m0, s75, 49152
    s_add_u32 s70, s100, 458752
    buffer_load_dwordx4 v236, s[32:35], s70 offen lds
    v_permlane32_swap_b32 v220, v222
    v_permlane32_swap_b32 v221, v223
    v_permlane32_swap_b32 v224, v226
    v_permlane32_swap_b32 v225, v227
    s_mov_b64 vcc, s[52:53]
    v_cndmask_b32_dpp v16, v222, v220, vcc quad_perm:[2,3,0,1] row_mask:0xf bank_mask:0xf
    v_cndmask_b32_dpp v17, v223, v221, vcc quad_perm:[2,3,0,1] row_mask:0xf bank_mask:0xf
    v_cndmask_b32_dpp v20, v226, v224, vcc quad_perm:[2,3,0,1] row_mask:0xf bank_mask:0xf
    v_cndmask_b32_dpp v21, v227, v225, vcc quad_perm:[2,3,0,1] row_mask:0xf bank_mask:0xf
    s_add_u32 m0, s75, 50176
    s_add_u32 s70, s100, 460800
    buffer_load_dwordx4 v236, s[32:35], s70 offen lds
    s_mov_b64 vcc, s[54:55]
    v_cndmask_b32_dpp v18, v220, v222, vcc quad_perm:[2,3,0,1] row_mask:0xf bank_mask:0xf
    v_cndmask_b32_dpp v19, v221, v223, vcc quad_perm:[2,3,0,1] row_mask:0xf bank_mask:0xf
    v_cndmask_b32_dpp v22, v224, v226, vcc quad_perm:[2,3,0,1] row_mask:0xf bank_mask:0xf
    v_cndmask_b32_dpp v23, v225, v227, vcc quad_perm:[2,3,0,1] row_mask:0xf bank_mask:0xf
    s_add_u32 m0, s75, 51200
    s_add_u32 s70, s100, 462848
    buffer_load_dwordx4 v237, s[32:35], s70 offen lds
    s_add_u32 m0, s75, 52224
    s_add_u32 s70, s100, 464896
    buffer_load_dwordx4 v237, s[32:35], s70 offen lds
    s_waitcnt vmcnt(16)
    s_barrier
    s_add_u32 m0, s73, 0
    v_lshl_add_u32 v34, v34, 7, v240
    buffer_load_dwordx4 v34, s[28:31], 0 offen lds
    s_add_u32 m0, s73, 1024
    v_lshl_add_u32 v36, v36, 7, v241
    buffer_load_dwordx4 v36, s[28:31], 0 offen lds
    s_add_u32 m0, s73, 2048
    v_lshl_add_u32 v38, v38, 7, v240
    buffer_load_dwordx4 v38, s[28:31], 0 offen lds
    s_add_u32 m0, s73, 3072
    v_lshl_add_u32 v82, v82, 7, v241
    buffer_load_dwordx4 v82, s[28:31], 0 offen lds
    s_mov_b64 vcc, s[48:49]
    v_cndmask_b32_dpp v220, v68, v64, vcc quad_perm:[1,0,3,2] row_mask:0xf bank_mask:0xf
    v_cndmask_b32_dpp v221, v69, v65, vcc quad_perm:[1,0,3,2] row_mask:0xf bank_mask:0xf
    v_cndmask_b32_dpp v222, v70, v66, vcc quad_perm:[1,0,3,2] row_mask:0xf bank_mask:0xf
    v_cndmask_b32_dpp v223, v71, v67, vcc quad_perm:[1,0,3,2] row_mask:0xf bank_mask:0xf
    s_mov_b64 vcc, s[50:51]
    v_cndmask_b32_dpp v224, v64, v68, vcc quad_perm:[1,0,3,2] row_mask:0xf bank_mask:0xf
    v_cndmask_b32_dpp v225, v65, v69, vcc quad_perm:[1,0,3,2] row_mask:0xf bank_mask:0xf
    v_cndmask_b32_dpp v226, v66, v70, vcc quad_perm:[1,0,3,2] row_mask:0xf bank_mask:0xf
    v_cndmask_b32_dpp v227, v67, v71, vcc quad_perm:[1,0,3,2] row_mask:0xf bank_mask:0xf
    s_add_u32 m0, s75, 0
    s_add_u32 s70, s101, 491520
    buffer_load_dwordx4 v236, s[32:35], s70 offen lds
    v_permlane32_swap_b32 v220, v222
    v_permlane32_swap_b32 v221, v223
    v_permlane32_swap_b32 v224, v226
    v_permlane32_swap_b32 v225, v227
    s_mov_b64 vcc, s[52:53]
    v_cndmask_b32_dpp v64, v222, v220, vcc quad_perm:[2,3,0,1] row_mask:0xf bank_mask:0xf
    v_cndmask_b32_dpp v65, v223, v221, vcc quad_perm:[2,3,0,1] row_mask:0xf bank_mask:0xf
    v_cndmask_b32_dpp v68, v226, v224, vcc quad_perm:[2,3,0,1] row_mask:0xf bank_mask:0xf
    v_cndmask_b32_dpp v69, v227, v225, vcc quad_perm:[2,3,0,1] row_mask:0xf bank_mask:0xf
    s_add_u32 m0, s75, 1024
    s_add_u32 s70, s101, 493568
    buffer_load_dwordx4 v236, s[32:35], s70 offen lds
    s_mov_b64 vcc, s[54:55]
    v_cndmask_b32_dpp v66, v220, v222, vcc quad_perm:[2,3,0,1] row_mask:0xf bank_mask:0xf
    v_cndmask_b32_dpp v67, v221, v223, vcc quad_perm:[2,3,0,1] row_mask:0xf bank_mask:0xf
    v_cndmask_b32_dpp v70, v224, v226, vcc quad_perm:[2,3,0,1] row_mask:0xf bank_mask:0xf
    v_cndmask_b32_dpp v71, v225, v227, vcc quad_perm:[2,3,0,1] row_mask:0xf bank_mask:0xf
    s_add_u32 m0, s75, 2048
    s_add_u32 s70, s101, 495616
    buffer_load_dwordx4 v237, s[32:35], s70 offen lds
    s_add_u32 m0, s75, 3072
    s_add_u32 s70, s101, 497664
    buffer_load_dwordx4 v237, s[32:35], s70 offen lds
    s_waitcnt vmcnt(16)
    s_barrier
    s_add_u32 m0, s73, 16384
    v_lshl_add_u32 v85, v85, 7, v240
    buffer_load_dwordx4 v85, s[28:31], 0 offen lds
    s_add_u32 m0, s73, 17408
    v_lshl_add_u32 v87, v87, 7, v241
    buffer_load_dwordx4 v87, s[28:31], 0 offen lds
    s_add_u32 m0, s73, 18432
    v_lshl_add_u32 v131, v131, 7, v240
    buffer_load_dwordx4 v131, s[28:31], 0 offen lds
    s_add_u32 m0, s73, 19456
    v_lshl_add_u32 v133, v133, 7, v241
    buffer_load_dwordx4 v133, s[28:31], 0 offen lds
    s_mov_b64 vcc, s[48:49]
    v_cndmask_b32_dpp v220, v116, v112, vcc quad_perm:[1,0,3,2] row_mask:0xf bank_mask:0xf
    v_cndmask_b32_dpp v221, v117, v113, vcc quad_perm:[1,0,3,2] row_mask:0xf bank_mask:0xf
    v_cndmask_b32_dpp v222, v118, v114, vcc quad_perm:[1,0,3,2] row_mask:0xf bank_mask:0xf
    v_cndmask_b32_dpp v223, v119, v115, vcc quad_perm:[1,0,3,2] row_mask:0xf bank_mask:0xf
    s_mov_b64 vcc, s[50:51]
    v_cndmask_b32_dpp v224, v112, v116, vcc quad_perm:[1,0,3,2] row_mask:0xf bank_mask:0xf
    v_cndmask_b32_dpp v225, v113, v117, vcc quad_perm:[1,0,3,2] row_mask:0xf bank_mask:0xf
    v_cndmask_b32_dpp v226, v114, v118, vcc quad_perm:[1,0,3,2] row_mask:0xf bank_mask:0xf
    v_cndmask_b32_dpp v227, v115, v119, vcc quad_perm:[1,0,3,2] row_mask:0xf bank_mask:0xf
    s_add_u32 m0, s75, 16384
    s_add_u32 s70, s100, 524288
    buffer_load_dwordx4 v236, s[32:35], s70 offen lds
    v_permlane32_swap_b32 v220, v222
    v_permlane32_swap_b32 v221, v223
    v_permlane32_swap_b32 v224, v226
    v_permlane32_swap_b32 v225, v227
    s_mov_b64 vcc, s[52:53]
    v_cndmask_b32_dpp v112, v222, v220, vcc quad_perm:[2,3,0,1] row_mask:0xf bank_mask:0xf
    v_cndmask_b32_dpp v113, v223, v221, vcc quad_perm:[2,3,0,1] row_mask:0xf bank_mask:0xf
    v_cndmask_b32_dpp v116, v226, v224, vcc quad_perm:[2,3,0,1] row_mask:0xf bank_mask:0xf
    v_cndmask_b32_dpp v117, v227, v225, vcc quad_perm:[2,3,0,1] row_mask:0xf bank_mask:0xf
    s_add_u32 m0, s75, 17408
    s_add_u32 s70, s100, 526336
    buffer_load_dwordx4 v236, s[32:35], s70 offen lds
    s_mov_b64 vcc, s[54:55]
    v_cndmask_b32_dpp v114, v220, v222, vcc quad_perm:[2,3,0,1] row_mask:0xf bank_mask:0xf
    v_cndmask_b32_dpp v115, v221, v223, vcc quad_perm:[2,3,0,1] row_mask:0xf bank_mask:0xf
    v_cndmask_b32_dpp v118, v224, v226, vcc quad_perm:[2,3,0,1] row_mask:0xf bank_mask:0xf
    v_cndmask_b32_dpp v119, v225, v227, vcc quad_perm:[2,3,0,1] row_mask:0xf bank_mask:0xf
    s_add_u32 m0, s75, 18432
    s_add_u32 s70, s100, 528384
    buffer_load_dwordx4 v237, s[32:35], s70 offen lds
    s_add_u32 m0, s75, 19456
    s_add_u32 s70, s100, 530432
    buffer_load_dwordx4 v237, s[32:35], s70 offen lds
    s_waitcnt vmcnt(16)
    s_barrier
    s_add_u32 m0, s73, 32768
    v_lshl_add_u32 v35, v35, 7, v240
    buffer_load_dwordx4 v35, s[28:31], 0 offen lds
    s_add_u32 m0, s73, 33792
    v_lshl_add_u32 v37, v37, 7, v241
    buffer_load_dwordx4 v37, s[28:31], 0 offen lds
    s_add_u32 m0, s73, 34816
    v_lshl_add_u32 v39, v39, 7, v240
    buffer_load_dwordx4 v39, s[28:31], 0 offen lds
    s_add_u32 m0, s73, 35840
    v_lshl_add_u32 v83, v83, 7, v241
    buffer_load_dwordx4 v83, s[28:31], 0 offen lds
    s_mov_b64 vcc, s[48:49]
    v_cndmask_b32_dpp v220, v164, v160, vcc quad_perm:[1,0,3,2] row_mask:0xf bank_mask:0xf
    v_cndmask_b32_dpp v221, v165, v161, vcc quad_perm:[1,0,3,2] row_mask:0xf bank_mask:0xf
    v_cndmask_b32_dpp v222, v166, v162, vcc quad_perm:[1,0,3,2] row_mask:0xf bank_mask:0xf
    v_cndmask_b32_dpp v223, v167, v163, vcc quad_perm:[1,0,3,2] row_mask:0xf bank_mask:0xf
    s_mov_b64 vcc, s[50:51]
    v_cndmask_b32_dpp v224, v160, v164, vcc quad_perm:[1,0,3,2] row_mask:0xf bank_mask:0xf
    v_cndmask_b32_dpp v225, v161, v165, vcc quad_perm:[1,0,3,2] row_mask:0xf bank_mask:0xf
    v_cndmask_b32_dpp v226, v162, v166, vcc quad_perm:[1,0,3,2] row_mask:0xf bank_mask:0xf
    v_cndmask_b32_dpp v227, v163, v167, vcc quad_perm:[1,0,3,2] row_mask:0xf bank_mask:0xf
    s_add_u32 m0, s75, 32768
    s_add_u32 s70, s101, 557056
    buffer_load_dwordx4 v236, s[32:35], s70 offen lds
    v_permlane32_swap_b32 v220, v222
    v_permlane32_swap_b32 v221, v223
    v_permlane32_swap_b32 v224, v226
    v_permlane32_swap_b32 v225, v227
    s_mov_b64 vcc, s[52:53]
    v_cndmask_b32_dpp v160, v222, v220, vcc quad_perm:[2,3,0,1] row_mask:0xf bank_mask:0xf
    v_cndmask_b32_dpp v161, v223, v221, vcc quad_perm:[2,3,0,1] row_mask:0xf bank_mask:0xf
    v_cndmask_b32_dpp v164, v226, v224, vcc quad_perm:[2,3,0,1] row_mask:0xf bank_mask:0xf
    v_cndmask_b32_dpp v165, v227, v225, vcc quad_perm:[2,3,0,1] row_mask:0xf bank_mask:0xf
    s_add_u32 m0, s75, 33792
    s_add_u32 s70, s101, 559104
    buffer_load_dwordx4 v236, s[32:35], s70 offen lds
    s_mov_b64 vcc, s[54:55]
    v_cndmask_b32_dpp v162, v220, v222, vcc quad_perm:[2,3,0,1] row_mask:0xf bank_mask:0xf
    v_cndmask_b32_dpp v163, v221, v223, vcc quad_perm:[2,3,0,1] row_mask:0xf bank_mask:0xf
    v_cndmask_b32_dpp v166, v224, v226, vcc quad_perm:[2,3,0,1] row_mask:0xf bank_mask:0xf
    v_cndmask_b32_dpp v167, v225, v227, vcc quad_perm:[2,3,0,1] row_mask:0xf bank_mask:0xf
    s_add_u32 m0, s75, 34816
    s_add_u32 s70, s101, 561152
    buffer_load_dwordx4 v237, s[32:35], s70 offen lds
    s_add_u32 m0, s75, 35840
    s_add_u32 s70, s101, 563200
    buffer_load_dwordx4 v237, s[32:35], s70 offen lds
    s_waitcnt vmcnt(16)
    s_barrier
    s_add_u32 m0, s73, 49152
    v_lshl_add_u32 v126, v126, 7, v240
    buffer_load_dwordx4 v126, s[28:31], 0 offen lds
    s_add_u32 m0, s73, 50176
    v_lshl_add_u32 v170, v170, 7, v241
    buffer_load_dwordx4 v170, s[28:31], 0 offen lds
    s_add_u32 m0, s73, 51200
    v_lshl_add_u32 v172, v172, 7, v240
    buffer_load_dwordx4 v172, s[28:31], 0 offen lds
    s_add_u32 m0, s73, 52224
    v_lshl_add_u32 v174, v174, 7, v241
    buffer_load_dwordx4 v174, s[28:31], 0 offen lds
    s_add_u32 m0, s75, 49152
    s_add_u32 s70, s100, 589824
    buffer_load_dwordx4 v236, s[32:35], s70 offen lds
    s_add_u32 m0, s75, 50176
    s_add_u32 s70, s100, 591872
    buffer_load_dwordx4 v236, s[32:35], s70 offen lds
    s_add_u32 m0, s75, 51200
    s_add_u32 s70, s100, 593920
    buffer_load_dwordx4 v237, s[32:35], s70 offen lds
    s_add_u32 m0, s75, 52224
    s_add_u32 s70, s100, 595968
    buffer_load_dwordx4 v237, s[32:35], s70 offen lds
    s_waitcnt vmcnt(16)
    s_barrier
    s_add_u32 m0, s73, 0
    v_lshl_add_u32 v76, v76, 7, v240
    buffer_load_dwordx4 v76, s[28:31], 0 offen lds
    s_add_u32 m0, s73, 1024
    v_lshl_add_u32 v78, v78, 7, v241
    buffer_load_dwordx4 v78, s[28:31], 0 offen lds
    s_add_u32 m0, s73, 2048
    v_lshl_add_u32 v122, v122, 7, v240
    buffer_load_dwordx4 v122, s[28:31], 0 offen lds
    s_add_u32 m0, s73, 3072
    v_lshl_add_u32 v124, v124, 7, v241
    buffer_load_dwordx4 v124, s[28:31], 0 offen lds
    s_add_u32 m0, s75, 0
    s_add_u32 s70, s101, 622592
    buffer_load_dwordx4 v236, s[32:35], s70 offen lds
    s_add_u32 m0, s75, 1024
    s_add_u32 s70, s101, 624640
    buffer_load_dwordx4 v236, s[32:35], s70 offen lds
    s_add_u32 m0, s75, 2048
    s_add_u32 s70, s101, 626688
    buffer_load_dwordx4 v237, s[32:35], s70 offen lds
    s_add_u32 m0, s75, 3072
    s_add_u32 s70, s101, 628736
    buffer_load_dwordx4 v237, s[32:35], s70 offen lds
    s_waitcnt vmcnt(16)
    s_barrier
    s_add_u32 m0, s73, 16384
    v_lshl_add_u32 v127, v127, 7, v240
    buffer_load_dwordx4 v127, s[28:31], 0 offen lds
    s_add_u32 m0, s73, 17408
    v_lshl_add_u32 v171, v171, 7, v241
    buffer_load_dwordx4 v171, s[28:31], 0 offen lds
    s_add_u32 m0, s73, 18432
    v_lshl_add_u32 v173, v173, 7, v240
    buffer_load_dwordx4 v173, s[28:31], 0 offen lds
    s_add_u32 m0, s73, 19456
    v_lshl_add_u32 v175, v175, 7, v241
    buffer_load_dwordx4 v175, s[28:31], 0 offen lds
    s_add_u32 m0, s75, 16384
    s_add_u32 s70, s100, 655360
    buffer_load_dwordx4 v236, s[32:35], s70 offen lds
    s_add_u32 m0, s75, 17408
    s_add_u32 s70, s100, 657408
    buffer_load_dwordx4 v236, s[32:35], s70 offen lds
    s_add_u32 m0, s75, 18432
    s_add_u32 s70, s100, 659456
    buffer_load_dwordx4 v237, s[32:35], s70 offen lds
    s_add_u32 m0, s75, 19456
    s_add_u32 s70, s100, 661504
    buffer_load_dwordx4 v237, s[32:35], s70 offen lds
    s_waitcnt vmcnt(16)
    s_barrier
    s_add_u32 m0, s73, 32768
    v_lshl_add_u32 v77, v77, 7, v240
    buffer_load_dwordx4 v77, s[28:31], 0 offen lds
    s_add_u32 m0, s73, 33792
    v_lshl_add_u32 v79, v79, 7, v241
    buffer_load_dwordx4 v79, s[28:31], 0 offen lds
    s_add_u32 m0, s73, 34816
    v_lshl_add_u32 v123, v123, 7, v240
    buffer_load_dwordx4 v123, s[28:31], 0 offen lds
    s_add_u32 m0, s73, 35840
    v_lshl_add_u32 v125, v125, 7, v241
    buffer_load_dwordx4 v125, s[28:31], 0 offen lds
    s_add_u32 m0, s75, 32768
    s_add_u32 s70, s101, 688128
    buffer_load_dwordx4 v236, s[32:35], s70 offen lds
    s_add_u32 m0, s75, 33792
    s_add_u32 s70, s101, 690176
    buffer_load_dwordx4 v236, s[32:35], s70 offen lds
    s_add_u32 m0, s75, 34816
    s_add_u32 s70, s101, 692224
    buffer_load_dwordx4 v237, s[32:35], s70 offen lds
    s_add_u32 m0, s75, 35840
    s_add_u32 s70, s101, 694272
    buffer_load_dwordx4 v237, s[32:35], s70 offen lds
    s_waitcnt vmcnt(16)
    s_barrier
    s_add_u32 m0, s73, 49152
    v_lshl_add_u32 v26, v26, 7, v240
    buffer_load_dwordx4 v26, s[28:31], 0 offen lds
    s_add_u32 m0, s73, 50176
    v_lshl_add_u32 v28, v28, 7, v241
    buffer_load_dwordx4 v28, s[28:31], 0 offen lds
    s_add_u32 m0, s73, 51200
    v_lshl_add_u32 v30, v30, 7, v240
    buffer_load_dwordx4 v30, s[28:31], 0 offen lds
    s_add_u32 m0, s73, 52224
    v_lshl_add_u32 v74, v74, 7, v241
    buffer_load_dwordx4 v74, s[28:31], 0 offen lds
    s_add_u32 m0, s75, 49152
    s_add_u32 s70, s100, 720896
    buffer_load_dwordx4 v236, s[32:35], s70 offen lds
    s_add_u32 m0, s75, 50176
    s_add_u32 s70, s100, 722944
    buffer_load_dwordx4 v236, s[32:35], s70 offen lds
    s_add_u32 m0, s75, 51200
    s_add_u32 s70, s100, 724992
    buffer_load_dwordx4 v237, s[32:35], s70 offen lds
    s_add_u32 m0, s75, 52224
    s_add_u32 s70, s100, 727040
    buffer_load_dwordx4 v237, s[32:35], s70 offen lds
    s_waitcnt vmcnt(16)
    s_barrier
    s_add_u32 m0, s73, 0
    v_lshl_add_u32 v27, v27, 7, v240
    buffer_load_dwordx4 v27, s[28:31], 0 offen lds
    s_add_u32 m0, s73, 1024
    v_lshl_add_u32 v29, v29, 7, v241
    buffer_load_dwordx4 v29, s[28:31], 0 offen lds
    s_add_u32 m0, s73, 2048
    v_lshl_add_u32 v31, v31, 7, v240
    buffer_load_dwordx4 v31, s[28:31], 0 offen lds
    s_add_u32 m0, s73, 3072
    v_lshl_add_u32 v75, v75, 7, v241
    buffer_load_dwordx4 v75, s[28:31], 0 offen lds
    s_add_u32 m0, s75, 0
    s_add_u32 s70, s96, 753664
    buffer_load_dwordx4 v236, s[32:35], s70 offen lds
    s_add_u32 m0, s75, 1024
    s_add_u32 s70, s96, 755712
    buffer_load_dwordx4 v236, s[32:35], s70 offen lds
    s_add_u32 m0, s75, 2048
    s_add_u32 s70, s96, 757760
    buffer_load_dwordx4 v237, s[32:35], s70 offen lds
    s_add_u32 m0, s75, 3072
    s_add_u32 s70, s96, 759808
    buffer_load_dwordx4 v237, s[32:35], s70 offen lds
    s_waitcnt vmcnt(16)
    s_barrier
    s_add_u32 m0, s73, 16384
    v_lshl_add_u32 v24, v24, 7, v240
    buffer_load_dwordx4 v24, s[28:31], 0 offen lds
    s_add_u32 m0, s73, 17408
    v_lshl_add_u32 v25, v25, 7, v241
    buffer_load_dwordx4 v25, s[28:31], 0 offen lds
    s_add_u32 m0, s73, 18432
    v_lshl_add_u32 v72, v72, 7, v240
    buffer_load_dwordx4 v72, s[28:31], 0 offen lds
    s_add_u32 m0, s73, 19456
    v_lshl_add_u32 v73, v73, 7, v241
    buffer_load_dwordx4 v73, s[28:31], 0 offen lds
    v_mbcnt_lo_u32_b32 v227, -1, 0
    v_mbcnt_hi_u32_b32 v227, -1, v227
    v_bfe_u32 v221, v227, 1, 3
    v_bfe_u32 v222, v227, 4, 1
    v_lshlrev_b32 v222, 2, v222
    v_xor_b32 v221, v221, v222
    v_lshlrev_b32 v221, 4, v221
    v_and_b32 v222, 15, v227
    v_lshl_add_u32 v221, v222, 7, v221
    v_lshrrev_b32 v222, 5, v227
    v_lshl_add_u32 v221, v222, 3, v221
    v_add_u32 v220, s73, v221
    v_xor_b32 v221, 16, v220
    v_xor_b32 v222, 32, v220
    v_xor_b32 v223, 48, v220
    v_add_u32 v224, 65536, v220
    v_add_u32 v225, 65536, v221
    v_add_u32 v226, 65536, v222
    v_add_u32 v227, 65536, v223
    s_add_u32 m0, s75, 16384
    v_lshl_add_u32 v120, v120, 7, v240
    buffer_load_dwordx4 v120, s[28:31], 0 offen lds
    s_add_u32 m0, s75, 17408
    v_lshl_add_u32 v121, v121, 7, v241
    buffer_load_dwordx4 v121, s[28:31], 0 offen lds
    s_add_u32 m0, s75, 18432
    v_lshl_add_u32 v168, v168, 7, v240
    buffer_load_dwordx4 v168, s[28:31], 0 offen lds
    s_add_u32 m0, s75, 19456
    v_lshl_add_u32 v169, v169, 7, v241
    buffer_load_dwordx4 v169, s[28:31], 0 offen lds
    s_waitcnt vmcnt(8)
    s_barrier
    s_add_u32 m0, s73, 32768
    v_lshl_add_u32 v32, v32, 7, v240
    buffer_load_dwordx4 v32, s[28:31], 0 offen lds
    s_add_u32 m0, s73, 33792
    v_lshl_add_u32 v33, v33, 7, v241
    buffer_load_dwordx4 v33, s[28:31], 0 offen lds
    s_add_u32 m0, s73, 34816
    v_lshl_add_u32 v80, v80, 7, v240
    buffer_load_dwordx4 v80, s[28:31], 0 offen lds
    s_add_u32 m0, s73, 35840
    v_lshl_add_u32 v81, v81, 7, v241
    buffer_load_dwordx4 v81, s[28:31], 0 offen lds
    s_add_u32 m0, s75, 32768
    v_lshl_add_u32 v128, v128, 7, v240
    buffer_load_dwordx4 v128, s[28:31], 0 offen lds
    s_add_u32 m0, s75, 33792
    v_lshl_add_u32 v129, v129, 7, v241
    buffer_load_dwordx4 v129, s[28:31], 0 offen lds
    s_add_u32 m0, s75, 34816
    v_lshl_add_u32 v176, v176, 7, v240
    buffer_load_dwordx4 v176, s[28:31], 0 offen lds
    s_add_u32 m0, s75, 35840
    v_lshl_add_u32 v177, v177, 7, v241
    buffer_load_dwordx4 v177, s[28:31], 0 offen lds
    s_waitcnt vmcnt(8)
    ds_read_b64 v[24:25], v220 offset:16384
    ds_read_b64 v[26:27], v222 offset:16384
    ds_read_b64 v[28:29], v221 offset:16384
    ds_read_b64 v[30:31], v223 offset:16384
    ds_read_b64 v[72:73], v220 offset:18432
    ds_read_b64 v[74:75], v222 offset:18432
    ds_read_b64 v[76:77], v221 offset:18432
    ds_read_b64 v[78:79], v223 offset:18432
    ds_read_b64 v[120:121], v224 offset:16384
    ds_read_b64 v[122:123], v226 offset:16384
    ds_read_b64 v[124:125], v225 offset:16384
    ds_read_b64 v[126:127], v227 offset:16384
    ds_read_b64 v[168:169], v224 offset:18432
    ds_read_b64 v[170:171], v226 offset:18432
    ds_read_b64 v[172:173], v225 offset:18432
    ds_read_b64 v[174:175], v227 offset:18432
    s_waitcnt lgkmcnt(0)
    s_add_u32 m0, s73, 16384
    v_lshl_add_u32 v40, v40, 7, v240
    buffer_load_dwordx4 v40, s[28:31], 0 offen lds
    s_add_u32 m0, s73, 17408
    v_lshl_add_u32 v41, v41, 7, v241
    buffer_load_dwordx4 v41, s[28:31], 0 offen lds
    s_add_u32 m0, s73, 18432
    v_lshl_add_u32 v88, v88, 7, v240
    buffer_load_dwordx4 v88, s[28:31], 0 offen lds
    s_add_u32 m0, s73, 19456
    v_lshl_add_u32 v89, v89, 7, v241
    buffer_load_dwordx4 v89, s[28:31], 0 offen lds
    s_add_u32 m0, s75, 16384
    v_lshl_add_u32 v136, v136, 7, v240
    buffer_load_dwordx4 v136, s[28:31], 0 offen lds
    s_add_u32 m0, s75, 17408
    v_lshl_add_u32 v137, v137, 7, v241
    buffer_load_dwordx4 v137, s[28:31], 0 offen lds
    s_add_u32 m0, s75, 18432
    v_lshl_add_u32 v184, v184, 7, v240
    buffer_load_dwordx4 v184, s[28:31], 0 offen lds
    s_add_u32 m0, s75, 19456
    v_lshl_add_u32 v185, v185, 7, v241
    buffer_load_dwordx4 v185, s[28:31], 0 offen lds
    ds_read_b128 v[208:211], v238 offset:21504
    v_mfma_f32_16x16x32_bf16 v[192:195], v[228:231], v[228:231], 0
    v_mfma_f32_16x16x32_bf16 v[192:195], v[232:235], v[232:235], v[192:195]
    ds_read_b32 v212, v239 offset:0
    s_waitcnt lgkmcnt(1)
    s_nop 5
    v_fmac_f32 v216, v192, v208
    v_fmac_f32 v217, v193, v209
    v_fmac_f32 v218, v194, v210
    v_fmac_f32 v219, v195, v211
    v_mfma_f32_16x16x32_bf16 v[192:195], v[228:231], v[0:3], 0
    v_mfma_f32_16x16x32_bf16 v[192:195], v[232:235], v[4:7], v[192:195]
    v_mfma_f32_16x16x32_bf16 v[196:199], v[228:231], v[48:51], 0
    v_mfma_f32_16x16x32_bf16 v[196:199], v[232:235], v[52:55], v[196:199]
    v_mfma_f32_16x16x32_bf16 v[200:203], v[228:231], v[96:99], 0
    v_mfma_f32_16x16x32_bf16 v[200:203], v[232:235], v[100:103], v[200:203]
    s_waitcnt lgkmcnt(0)
    s_nop 2
    v_mfma_f32_16x16x32_bf16 v[204:207], v[228:231], v[144:147], 0
    v_fmac_f32 v216, v192, v212
    v_mfma_f32_16x16x32_bf16 v[204:207], v[232:235], v[148:151], v[204:207]
    ds_read_b128 v[208:211], v238 offset:0
    v_mfma_f32_16x16x32_bf16 v[192:195], v[0:3], v[0:3], 0
    v_fmac_f32 v217, v197, v212
    v_mfma_f32_16x16x32_bf16 v[192:195], v[4:7], v[4:7], v[192:195]
    v_mfma_f32_16x16x32_bf16 v[196:199], v[48:51], v[48:51], 0
    v_fmac_f32 v218, v202, v212
    v_mfma_f32_16x16x32_bf16 v[196:199], v[52:55], v[52:55], v[196:199]
    s_nop 0
    v_mfma_f32_16x16x32_bf16 v[200:203], v[96:99], v[96:99], 0
    v_fmac_f32 v219, v207, v212
    v_mfma_f32_16x16x32_bf16 v[200:203], v[100:103], v[100:103], v[200:203]
    s_waitcnt lgkmcnt(0)
    v_mfma_f32_16x16x32_bf16 v[204:207], v[144:147], v[144:147], 0
    v_fmac_f32 v216, v192, v208
    v_fmac_f32 v216, v193, v209
    v_mfma_f32_16x16x32_bf16 v[204:207], v[148:151], v[148:151], v[204:207]
    v_fmac_f32 v216, v194, v210
    v_fmac_f32 v216, v195, v211
    ds_read_b32 v212, v239 offset:256
    v_mfma_f32_16x16x32_bf16 v[192:195], v[228:231], v[8:11], 0
    v_fmac_f32 v217, v196, v208
    v_fmac_f32 v217, v197, v209
    v_mfma_f32_16x16x32_bf16 v[192:195], v[232:235], v[12:15], v[192:195]
    v_fmac_f32 v217, v198, v210
    v_fmac_f32 v217, v199, v211
    v_mfma_f32_16x16x32_bf16 v[196:199], v[228:231], v[56:59], 0
    v_fmac_f32 v218, v200, v208
    v_fmac_f32 v218, v201, v209
    v_mfma_f32_16x16x32_bf16 v[196:199], v[232:235], v[60:63], v[196:199]
    v_fmac_f32 v218, v202, v210
    v_fmac_f32 v218, v203, v211
    v_mfma_f32_16x16x32_bf16 v[200:203], v[228:231], v[104:107], 0
    v_fmac_f32 v219, v204, v208
    v_fmac_f32 v219, v205, v209
    v_mfma_f32_16x16x32_bf16 v[200:203], v[232:235], v[108:111], v[200:203]
    v_fmac_f32 v219, v206, v210
    v_fmac_f32 v219, v207, v211
    s_waitcnt lgkmcnt(0)
    v_mfma_f32_16x16x32_bf16 v[204:207], v[228:231], v[152:155], 0
    v_fmac_f32 v216, v192, v212
    v_mfma_f32_16x16x32_bf16 v[204:207], v[232:235], v[156:159], v[204:207]
    ds_read_b128 v[208:211], v238 offset:1024
    v_mfma_f32_16x16x32_bf16 v[192:195], v[0:3], v[8:11], 0
    v_fmac_f32 v217, v197, v212
    v_mfma_f32_16x16x32_bf16 v[192:195], v[4:7], v[12:15], v[192:195]
    v_mfma_f32_16x16x32_bf16 v[196:199], v[48:51], v[56:59], 0
    v_fmac_f32 v218, v202, v212
    v_mfma_f32_16x16x32_bf16 v[196:199], v[52:55], v[60:63], v[196:199]
    s_nop 0
    v_mfma_f32_16x16x32_bf16 v[200:203], v[96:99], v[104:107], 0
    v_fmac_f32 v219, v207, v212
    v_mfma_f32_16x16x32_bf16 v[200:203], v[100:103], v[108:111], v[200:203]
    s_waitcnt lgkmcnt(0)
    v_mfma_f32_16x16x32_bf16 v[204:207], v[144:147], v[152:155], 0
    v_fmac_f32 v216, v192, v208
    v_fmac_f32 v216, v193, v209
    v_mfma_f32_16x16x32_bf16 v[204:207], v[148:151], v[156:159], v[204:207]
    v_fmac_f32 v216, v194, v210
    v_fmac_f32 v216, v195, v211
    ds_read_b128 v[212:215], v238 offset:2048
    v_mfma_f32_16x16x32_bf16 v[192:195], v[8:11], v[8:11], 0
    v_fmac_f32 v217, v196, v208
    v_fmac_f32 v217, v197, v209
    v_mfma_f32_16x16x32_bf16 v[192:195], v[12:15], v[12:15], v[192:195]
    v_fmac_f32 v217, v198, v210
    v_fmac_f32 v217, v199, v211
    v_mfma_f32_16x16x32_bf16 v[196:199], v[56:59], v[56:59], 0
    v_fmac_f32 v218, v200, v208
    v_fmac_f32 v218, v201, v209
    v_mfma_f32_16x16x32_bf16 v[196:199], v[60:63], v[60:63], v[196:199]
    v_fmac_f32 v218, v202, v210
    v_fmac_f32 v218, v203, v211
    v_mfma_f32_16x16x32_bf16 v[200:203], v[104:107], v[104:107], 0
    v_fmac_f32 v219, v204, v208
    v_fmac_f32 v219, v205, v209
    v_mfma_f32_16x16x32_bf16 v[200:203], v[108:111], v[108:111], v[200:203]
    v_fmac_f32 v219, v206, v210
    v_fmac_f32 v219, v207, v211
    s_waitcnt lgkmcnt(0)
    v_mfma_f32_16x16x32_bf16 v[204:207], v[152:155], v[152:155], 0
    v_fmac_f32 v216, v192, v212
    v_fmac_f32 v216, v193, v213
    v_mfma_f32_16x16x32_bf16 v[204:207], v[156:159], v[156:159], v[204:207]
    v_fmac_f32 v216, v194, v214
    v_fmac_f32 v216, v195, v215
    ds_read_b32 v208, v239 offset:512
    v_mfma_f32_16x16x32_bf16 v[192:195], v[228:231], v[16:19], 0
    v_fmac_f32 v217, v196, v212
    v_fmac_f32 v217, v197, v213
    v_mfma_f32_16x16x32_bf16 v[192:195], v[232:235], v[20:23], v[192:195]
    v_fmac_f32 v217, v198, v214
    v_fmac_f32 v217, v199, v215
    v_mfma_f32_16x16x32_bf16 v[196:199], v[228:231], v[64:67], 0
    v_fmac_f32 v218, v200, v212
    v_fmac_f32 v218, v201, v213
    v_mfma_f32_16x16x32_bf16 v[196:199], v[232:235], v[68:71], v[196:199]
    v_fmac_f32 v218, v202, v214
    v_fmac_f32 v218, v203, v215
    v_mfma_f32_16x16x32_bf16 v[200:203], v[228:231], v[112:115], 0
    v_fmac_f32 v219, v204, v212
    v_fmac_f32 v219, v205, v213
    v_mfma_f32_16x16x32_bf16 v[200:203], v[232:235], v[116:119], v[200:203]
    v_fmac_f32 v219, v206, v214
    v_fmac_f32 v219, v207, v215
    s_waitcnt lgkmcnt(0)
    v_mfma_f32_16x16x32_bf16 v[204:207], v[228:231], v[160:163], 0
    v_fmac_f32 v216, v192, v208
    v_mfma_f32_16x16x32_bf16 v[204:207], v[232:235], v[164:167], v[204:207]
    ds_read_b128 v[212:215], v238 offset:3072
    v_mfma_f32_16x16x32_bf16 v[192:195], v[0:3], v[16:19], 0
    v_fmac_f32 v217, v197, v208
    v_mfma_f32_16x16x32_bf16 v[192:195], v[4:7], v[20:23], v[192:195]
    v_mfma_f32_16x16x32_bf16 v[196:199], v[48:51], v[64:67], 0
    v_fmac_f32 v218, v202, v208
    v_mfma_f32_16x16x32_bf16 v[196:199], v[52:55], v[68:71], v[196:199]
    s_nop 0
    v_mfma_f32_16x16x32_bf16 v[200:203], v[96:99], v[112:115], 0
    v_fmac_f32 v219, v207, v208
    v_mfma_f32_16x16x32_bf16 v[200:203], v[100:103], v[116:119], v[200:203]
    s_waitcnt lgkmcnt(0)
    v_mfma_f32_16x16x32_bf16 v[204:207], v[144:147], v[160:163], 0
    v_fmac_f32 v216, v192, v212
    v_fmac_f32 v216, v193, v213
    v_mfma_f32_16x16x32_bf16 v[204:207], v[148:151], v[164:167], v[204:207]
    v_fmac_f32 v216, v194, v214
    v_fmac_f32 v216, v195, v215
    ds_read_b128 v[208:211], v238 offset:4096
    v_mfma_f32_16x16x32_bf16 v[192:195], v[8:11], v[16:19], 0
    v_fmac_f32 v217, v196, v212
    v_fmac_f32 v217, v197, v213
    v_mfma_f32_16x16x32_bf16 v[192:195], v[12:15], v[20:23], v[192:195]
    v_fmac_f32 v217, v198, v214
    v_fmac_f32 v217, v199, v215
    v_mfma_f32_16x16x32_bf16 v[196:199], v[56:59], v[64:67], 0
    v_fmac_f32 v218, v200, v212
    v_fmac_f32 v218, v201, v213
    v_mfma_f32_16x16x32_bf16 v[196:199], v[60:63], v[68:71], v[196:199]
    v_fmac_f32 v218, v202, v214
    v_fmac_f32 v218, v203, v215
    v_mfma_f32_16x16x32_bf16 v[200:203], v[104:107], v[112:115], 0
    v_fmac_f32 v219, v204, v212
    v_fmac_f32 v219, v205, v213
    v_mfma_f32_16x16x32_bf16 v[200:203], v[108:111], v[116:119], v[200:203]
    v_fmac_f32 v219, v206, v214
    v_fmac_f32 v219, v207, v215
    s_waitcnt lgkmcnt(0)
    v_mfma_f32_16x16x32_bf16 v[204:207], v[152:155], v[160:163], 0
    v_fmac_f32 v216, v192, v208
    v_fmac_f32 v216, v193, v209
    v_mfma_f32_16x16x32_bf16 v[204:207], v[156:159], v[164:167], v[204:207]
    v_fmac_f32 v216, v194, v210
    v_fmac_f32 v216, v195, v211
    ds_read_b128 v[212:215], v238 offset:5120
    v_mfma_f32_16x16x32_bf16 v[192:195], v[16:19], v[16:19], 0
    v_fmac_f32 v217, v196, v208
    v_fmac_f32 v217, v197, v209
    v_mfma_f32_16x16x32_bf16 v[192:195], v[20:23], v[20:23], v[192:195]
    v_fmac_f32 v217, v198, v210
    v_fmac_f32 v217, v199, v211
    v_mfma_f32_16x16x32_bf16 v[196:199], v[64:67], v[64:67], 0
    v_fmac_f32 v218, v200, v208
    v_fmac_f32 v218, v201, v209
    v_mfma_f32_16x16x32_bf16 v[196:199], v[68:71], v[68:71], v[196:199]
    v_fmac_f32 v218, v202, v210
    v_fmac_f32 v218, v203, v211
    v_mfma_f32_16x16x32_bf16 v[200:203], v[112:115], v[112:115], 0
    v_fmac_f32 v219, v204, v208
    v_fmac_f32 v219, v205, v209
    v_mfma_f32_16x16x32_bf16 v[200:203], v[116:119], v[116:119], v[200:203]
    v_fmac_f32 v219, v206, v210
    v_fmac_f32 v219, v207, v211
    s_waitcnt lgkmcnt(0)
    v_mfma_f32_16x16x32_bf16 v[204:207], v[160:163], v[160:163], 0
    v_fmac_f32 v216, v192, v212
    v_fmac_f32 v216, v193, v213
    v_mfma_f32_16x16x32_bf16 v[204:207], v[164:167], v[164:167], v[204:207]
    v_fmac_f32 v216, v194, v214
    v_fmac_f32 v216, v195, v215
    ds_read_b32 v208, v239 offset:768
    v_mfma_f32_16x16x32_bf16 v[192:195], v[228:231], v[24:27], 0
    v_fmac_f32 v217, v196, v212
    v_fmac_f32 v217, v197, v213
    v_mfma_f32_16x16x32_bf16 v[192:195], v[232:235], v[28:31], v[192:195]
    v_fmac_f32 v217, v198, v214
    v_fmac_f32 v217, v199, v215
    v_mfma_f32_16x16x32_bf16 v[196:199], v[228:231], v[72:75], 0
    v_fmac_f32 v218, v200, v212
    v_fmac_f32 v218, v201, v213
    v_mfma_f32_16x16x32_bf16 v[196:199], v[232:235], v[76:79], v[196:199]
    v_fmac_f32 v218, v202, v214
    v_fmac_f32 v218, v203, v215
    v_mfma_f32_16x16x32_bf16 v[200:203], v[228:231], v[120:123], 0
    v_fmac_f32 v219, v204, v212
    v_fmac_f32 v219, v205, v213
    v_mfma_f32_16x16x32_bf16 v[200:203], v[232:235], v[124:127], v[200:203]
    v_fmac_f32 v219, v206, v214
    v_fmac_f32 v219, v207, v215
    s_waitcnt lgkmcnt(0)
    v_mfma_f32_16x16x32_bf16 v[204:207], v[228:231], v[168:171], 0
    v_fmac_f32 v216, v192, v208
    v_mfma_f32_16x16x32_bf16 v[204:207], v[232:235], v[172:175], v[204:207]
    ds_read_b128 v[212:215], v238 offset:6144
    v_mfma_f32_16x16x32_bf16 v[192:195], v[0:3], v[24:27], 0
    v_fmac_f32 v217, v197, v208
    v_mfma_f32_16x16x32_bf16 v[192:195], v[4:7], v[28:31], v[192:195]
    v_mfma_f32_16x16x32_bf16 v[196:199], v[48:51], v[72:75], 0
    v_fmac_f32 v218, v202, v208
    v_mfma_f32_16x16x32_bf16 v[196:199], v[52:55], v[76:79], v[196:199]
    s_nop 0
    v_mfma_f32_16x16x32_bf16 v[200:203], v[96:99], v[120:123], 0
    v_fmac_f32 v219, v207, v208
    v_mfma_f32_16x16x32_bf16 v[200:203], v[100:103], v[124:127], v[200:203]
    s_waitcnt lgkmcnt(0)
    v_mfma_f32_16x16x32_bf16 v[204:207], v[144:147], v[168:171], 0
    v_fmac_f32 v216, v192, v212
    v_fmac_f32 v216, v193, v213
    v_mfma_f32_16x16x32_bf16 v[204:207], v[148:151], v[172:175], v[204:207]
    v_fmac_f32 v216, v194, v214
    v_fmac_f32 v216, v195, v215
    ds_read_b128 v[208:211], v238 offset:7168
    v_mfma_f32_16x16x32_bf16 v[192:195], v[8:11], v[24:27], 0
    v_fmac_f32 v217, v196, v212
    v_fmac_f32 v217, v197, v213
    v_mfma_f32_16x16x32_bf16 v[192:195], v[12:15], v[28:31], v[192:195]
    v_fmac_f32 v217, v198, v214
    v_fmac_f32 v217, v199, v215
    v_mfma_f32_16x16x32_bf16 v[196:199], v[56:59], v[72:75], 0
    v_fmac_f32 v218, v200, v212
    v_fmac_f32 v218, v201, v213
    v_mfma_f32_16x16x32_bf16 v[196:199], v[60:63], v[76:79], v[196:199]
    v_fmac_f32 v218, v202, v214
    v_fmac_f32 v218, v203, v215
    v_mfma_f32_16x16x32_bf16 v[200:203], v[104:107], v[120:123], 0
    v_fmac_f32 v219, v204, v212
    v_fmac_f32 v219, v205, v213
    v_mfma_f32_16x16x32_bf16 v[200:203], v[108:111], v[124:127], v[200:203]
    v_fmac_f32 v219, v206, v214
    v_fmac_f32 v219, v207, v215
    s_waitcnt lgkmcnt(0)
    v_mfma_f32_16x16x32_bf16 v[204:207], v[152:155], v[168:171], 0
    v_fmac_f32 v216, v192, v208
    v_fmac_f32 v216, v193, v209
    v_mfma_f32_16x16x32_bf16 v[204:207], v[156:159], v[172:175], v[204:207]
    v_fmac_f32 v216, v194, v210
    v_fmac_f32 v216, v195, v211
    ds_read_b128 v[212:215], v238 offset:8192
    v_mfma_f32_16x16x32_bf16 v[192:195], v[16:19], v[24:27], 0
    v_fmac_f32 v217, v196, v208
    v_fmac_f32 v217, v197, v209
    v_mfma_f32_16x16x32_bf16 v[192:195], v[20:23], v[28:31], v[192:195]
    v_fmac_f32 v217, v198, v210
    v_fmac_f32 v217, v199, v211
    v_mfma_f32_16x16x32_bf16 v[196:199], v[64:67], v[72:75], 0
    v_fmac_f32 v218, v200, v208
    v_fmac_f32 v218, v201, v209
    v_mfma_f32_16x16x32_bf16 v[196:199], v[68:71], v[76:79], v[196:199]
    v_fmac_f32 v218, v202, v210
    v_fmac_f32 v218, v203, v211
    v_mfma_f32_16x16x32_bf16 v[200:203], v[112:115], v[120:123], 0
    v_fmac_f32 v219, v204, v208
    v_fmac_f32 v219, v205, v209
    v_mfma_f32_16x16x32_bf16 v[200:203], v[116:119], v[124:127], v[200:203]
    v_fmac_f32 v219, v206, v210
    v_fmac_f32 v219, v207, v211
    s_waitcnt lgkmcnt(0)
    v_mfma_f32_16x16x32_bf16 v[204:207], v[160:163], v[168:171], 0
    v_fmac_f32 v216, v192, v212
    v_fmac_f32 v216, v193, v213
    v_mfma_f32_16x16x32_bf16 v[204:207], v[164:167], v[172:175], v[204:207]
    v_fmac_f32 v216, v194, v214
    v_fmac_f32 v216, v195, v215
    s_waitcnt vmcnt(8)
    ds_read_b64 v[32:33], v220 offset:32768
    ds_read_b64 v[34:35], v222 offset:32768
    ds_read_b64 v[36:37], v221 offset:32768
    ds_read_b64 v[38:39], v223 offset:32768
    ds_read_b64 v[80:81], v220 offset:34816
    ds_read_b64 v[82:83], v222 offset:34816
    ds_read_b64 v[84:85], v221 offset:34816
    ds_read_b64 v[86:87], v223 offset:34816
    ds_read_b64 v[128:129], v224 offset:32768
    ds_read_b64 v[130:131], v226 offset:32768
    ds_read_b64 v[132:133], v225 offset:32768
    ds_read_b64 v[134:135], v227 offset:32768
    ds_read_b64 v[176:177], v224 offset:34816
    ds_read_b64 v[178:179], v226 offset:34816
    ds_read_b64 v[180:181], v225 offset:34816
    ds_read_b64 v[182:183], v227 offset:34816
    ds_read_b128 v[208:211], v238 offset:9216
    v_mfma_f32_16x16x32_bf16 v[192:195], v[24:27], v[24:27], 0
    v_fmac_f32 v217, v196, v212
    v_fmac_f32 v217, v197, v213
    v_mfma_f32_16x16x32_bf16 v[192:195], v[28:31], v[28:31], v[192:195]
    v_fmac_f32 v217, v198, v214
    v_fmac_f32 v217, v199, v215
    v_mfma_f32_16x16x32_bf16 v[196:199], v[72:75], v[72:75], 0
    v_fmac_f32 v218, v200, v212
    v_fmac_f32 v218, v201, v213
    v_mfma_f32_16x16x32_bf16 v[196:199], v[76:79], v[76:79], v[196:199]
    v_fmac_f32 v218, v202, v214
    v_fmac_f32 v218, v203, v215
    v_mfma_f32_16x16x32_bf16 v[200:203], v[120:123], v[120:123], 0
    v_fmac_f32 v219, v204, v212
    v_fmac_f32 v219, v205, v213
    v_mfma_f32_16x16x32_bf16 v[200:203], v[124:127], v[124:127], v[200:203]
    v_fmac_f32 v219, v206, v214
    v_fmac_f32 v219, v207, v215
    s_waitcnt lgkmcnt(0)
    v_mfma_f32_16x16x32_bf16 v[204:207], v[168:171], v[168:171], 0
    v_fmac_f32 v216, v192, v208
    v_fmac_f32 v216, v193, v209
    v_mfma_f32_16x16x32_bf16 v[204:207], v[172:175], v[172:175], v[204:207]
    v_fmac_f32 v216, v194, v210
    v_fmac_f32 v216, v195, v211
    ds_read_b32 v212, v239 offset:1024
    v_mfma_f32_16x16x32_bf16 v[192:195], v[228:231], v[32:35], 0
    v_fmac_f32 v217, v196, v208
    v_fmac_f32 v217, v197, v209
    v_mfma_f32_16x16x32_bf16 v[192:195], v[232:235], v[36:39], v[192:195]
    v_fmac_f32 v217, v198, v210
    v_fmac_f32 v217, v199, v211
    v_mfma_f32_16x16x32_bf16 v[196:199], v[228:231], v[80:83], 0
    v_fmac_f32 v218, v200, v208
    v_fmac_f32 v218, v201, v209
    v_mfma_f32_16x16x32_bf16 v[196:199], v[232:235], v[84:87], v[196:199]
    v_fmac_f32 v218, v202, v210
    v_fmac_f32 v218, v203, v211
    v_mfma_f32_16x16x32_bf16 v[200:203], v[228:231], v[128:131], 0
    v_fmac_f32 v219, v204, v208
    v_fmac_f32 v219, v205, v209
    v_mfma_f32_16x16x32_bf16 v[200:203], v[232:235], v[132:135], v[200:203]
    v_fmac_f32 v219, v206, v210
    v_fmac_f32 v219, v207, v211
    s_waitcnt lgkmcnt(0)
    v_mfma_f32_16x16x32_bf16 v[204:207], v[228:231], v[176:179], 0
    v_fmac_f32 v216, v192, v212
    v_mfma_f32_16x16x32_bf16 v[204:207], v[232:235], v[180:183], v[204:207]
    ds_read_b128 v[208:211], v238 offset:10240
    v_mfma_f32_16x16x32_bf16 v[192:195], v[0:3], v[32:35], 0
    v_fmac_f32 v217, v197, v212
    v_mfma_f32_16x16x32_bf16 v[192:195], v[4:7], v[36:39], v[192:195]
    v_mfma_f32_16x16x32_bf16 v[196:199], v[48:51], v[80:83], 0
    v_fmac_f32 v218, v202, v212
    v_mfma_f32_16x16x32_bf16 v[196:199], v[52:55], v[84:87], v[196:199]
    s_nop 0
    v_mfma_f32_16x16x32_bf16 v[200:203], v[96:99], v[128:131], 0
    v_fmac_f32 v219, v207, v212
    v_mfma_f32_16x16x32_bf16 v[200:203], v[100:103], v[132:135], v[200:203]
    s_waitcnt lgkmcnt(0)
    v_mfma_f32_16x16x32_bf16 v[204:207], v[144:147], v[176:179], 0
    v_fmac_f32 v216, v192, v208
    v_fmac_f32 v216, v193, v209
    v_mfma_f32_16x16x32_bf16 v[204:207], v[148:151], v[180:183], v[204:207]
    v_fmac_f32 v216, v194, v210
    v_fmac_f32 v216, v195, v211
    ds_read_b128 v[212:215], v238 offset:11264
    v_mfma_f32_16x16x32_bf16 v[192:195], v[8:11], v[32:35], 0
    v_fmac_f32 v217, v196, v208
    v_fmac_f32 v217, v197, v209
    v_mfma_f32_16x16x32_bf16 v[192:195], v[12:15], v[36:39], v[192:195]
    v_fmac_f32 v217, v198, v210
    v_fmac_f32 v217, v199, v211
    v_mfma_f32_16x16x32_bf16 v[196:199], v[56:59], v[80:83], 0
    v_fmac_f32 v218, v200, v208
    v_fmac_f32 v218, v201, v209
    v_mfma_f32_16x16x32_bf16 v[196:199], v[60:63], v[84:87], v[196:199]
    v_fmac_f32 v218, v202, v210
    v_fmac_f32 v218, v203, v211
    v_mfma_f32_16x16x32_bf16 v[200:203], v[104:107], v[128:131], 0
    v_fmac_f32 v219, v204, v208
    v_fmac_f32 v219, v205, v209
    v_mfma_f32_16x16x32_bf16 v[200:203], v[108:111], v[132:135], v[200:203]
    v_fmac_f32 v219, v206, v210
    v_fmac_f32 v219, v207, v211
    s_waitcnt lgkmcnt(0)
    v_mfma_f32_16x16x32_bf16 v[204:207], v[152:155], v[176:179], 0
    v_fmac_f32 v216, v192, v212
    v_fmac_f32 v216, v193, v213
    v_mfma_f32_16x16x32_bf16 v[204:207], v[156:159], v[180:183], v[204:207]
    v_fmac_f32 v216, v194, v214
    v_fmac_f32 v216, v195, v215
    ds_read_b128 v[208:211], v238 offset:12288
    v_mfma_f32_16x16x32_bf16 v[192:195], v[16:19], v[32:35], 0
    v_fmac_f32 v217, v196, v212
    v_fmac_f32 v217, v197, v213
    v_mfma_f32_16x16x32_bf16 v[192:195], v[20:23], v[36:39], v[192:195]
    v_fmac_f32 v217, v198, v214
    v_fmac_f32 v217, v199, v215
    v_mfma_f32_16x16x32_bf16 v[196:199], v[64:67], v[80:83], 0
    v_fmac_f32 v218, v200, v212
    v_fmac_f32 v218, v201, v213
    v_mfma_f32_16x16x32_bf16 v[196:199], v[68:71], v[84:87], v[196:199]
    v_fmac_f32 v218, v202, v214
    v_fmac_f32 v218, v203, v215
    v_mfma_f32_16x16x32_bf16 v[200:203], v[112:115], v[128:131], 0
    v_fmac_f32 v219, v204, v212
    v_fmac_f32 v219, v205, v213
    v_mfma_f32_16x16x32_bf16 v[200:203], v[116:119], v[132:135], v[200:203]
    v_fmac_f32 v219, v206, v214
    v_fmac_f32 v219, v207, v215
    s_waitcnt lgkmcnt(0)
    v_mfma_f32_16x16x32_bf16 v[204:207], v[160:163], v[176:179], 0
    v_fmac_f32 v216, v192, v208
    v_fmac_f32 v216, v193, v209
    v_mfma_f32_16x16x32_bf16 v[204:207], v[164:167], v[180:183], v[204:207]
    v_fmac_f32 v216, v194, v210
    v_fmac_f32 v216, v195, v211
    ds_read_b128 v[212:215], v238 offset:13312
    v_mfma_f32_16x16x32_bf16 v[192:195], v[24:27], v[32:35], 0
    v_fmac_f32 v217, v196, v208
    v_fmac_f32 v217, v197, v209
    v_mfma_f32_16x16x32_bf16 v[192:195], v[28:31], v[36:39], v[192:195]
    v_fmac_f32 v217, v198, v210
    v_fmac_f32 v217, v199, v211
    v_mfma_f32_16x16x32_bf16 v[196:199], v[72:75], v[80:83], 0
    v_fmac_f32 v218, v200, v208
    v_fmac_f32 v218, v201, v209
    v_mfma_f32_16x16x32_bf16 v[196:199], v[76:79], v[84:87], v[196:199]
    v_fmac_f32 v218, v202, v210
    v_fmac_f32 v218, v203, v211
    v_mfma_f32_16x16x32_bf16 v[200:203], v[120:123], v[128:131], 0
    v_fmac_f32 v219, v204, v208
    v_fmac_f32 v219, v205, v209
    v_mfma_f32_16x16x32_bf16 v[200:203], v[124:127], v[132:135], v[200:203]
    v_fmac_f32 v219, v206, v210
    v_fmac_f32 v219, v207, v211
    s_waitcnt lgkmcnt(0)
    v_mfma_f32_16x16x32_bf16 v[204:207], v[168:171], v[176:179], 0
    v_fmac_f32 v216, v192, v212
    v_fmac_f32 v216, v193, v213
    v_mfma_f32_16x16x32_bf16 v[204:207], v[172:175], v[180:183], v[204:207]
    v_fmac_f32 v216, v194, v214
    v_fmac_f32 v216, v195, v215
    s_waitcnt vmcnt(0)
    ds_read_b64 v[40:41], v220 offset:16384
    ds_read_b64 v[42:43], v222 offset:16384
    ds_read_b64 v[44:45], v221 offset:16384
    ds_read_b64 v[46:47], v223 offset:16384
    ds_read_b64 v[88:89], v220 offset:18432
    ds_read_b64 v[90:91], v222 offset:18432
    ds_read_b64 v[92:93], v221 offset:18432
    ds_read_b64 v[94:95], v223 offset:18432
    ds_read_b64 v[136:137], v224 offset:16384
    ds_read_b64 v[138:139], v226 offset:16384
    ds_read_b64 v[140:141], v225 offset:16384
    ds_read_b64 v[142:143], v227 offset:16384
    ds_read_b64 v[184:185], v224 offset:18432
    ds_read_b64 v[186:187], v226 offset:18432
    ds_read_b64 v[188:189], v225 offset:18432
    ds_read_b64 v[190:191], v227 offset:18432
    ds_read_b128 v[208:211], v238 offset:14336
    v_mfma_f32_16x16x32_bf16 v[192:195], v[32:35], v[32:35], 0
    v_fmac_f32 v217, v196, v212
    v_fmac_f32 v217, v197, v213
    v_mfma_f32_16x16x32_bf16 v[192:195], v[36:39], v[36:39], v[192:195]
    v_fmac_f32 v217, v198, v214
    v_fmac_f32 v217, v199, v215
    v_mfma_f32_16x16x32_bf16 v[196:199], v[80:83], v[80:83], 0
    v_fmac_f32 v218, v200, v212
    v_fmac_f32 v218, v201, v213
    v_mfma_f32_16x16x32_bf16 v[196:199], v[84:87], v[84:87], v[196:199]
    v_fmac_f32 v218, v202, v214
    v_fmac_f32 v218, v203, v215
    v_mfma_f32_16x16x32_bf16 v[200:203], v[128:131], v[128:131], 0
    v_fmac_f32 v219, v204, v212
    v_fmac_f32 v219, v205, v213
    v_mfma_f32_16x16x32_bf16 v[200:203], v[132:135], v[132:135], v[200:203]
    v_fmac_f32 v219, v206, v214
    v_fmac_f32 v219, v207, v215
    s_waitcnt lgkmcnt(0)
    v_mfma_f32_16x16x32_bf16 v[204:207], v[176:179], v[176:179], 0
    v_fmac_f32 v216, v192, v208
    v_fmac_f32 v216, v193, v209
    v_mfma_f32_16x16x32_bf16 v[204:207], v[180:183], v[180:183], v[204:207]
    v_fmac_f32 v216, v194, v210
    v_fmac_f32 v216, v195, v211
    ds_read_b32 v212, v239 offset:1280
    v_mfma_f32_16x16x32_bf16 v[192:195], v[228:231], v[40:43], 0
    v_fmac_f32 v217, v196, v208
    v_fmac_f32 v217, v197, v209
    v_mfma_f32_16x16x32_bf16 v[192:195], v[232:235], v[44:47], v[192:195]
    v_fmac_f32 v217, v198, v210
    v_fmac_f32 v217, v199, v211
    v_mfma_f32_16x16x32_bf16 v[196:199], v[228:231], v[88:91], 0
    v_fmac_f32 v218, v200, v208
    v_fmac_f32 v218, v201, v209
    v_mfma_f32_16x16x32_bf16 v[196:199], v[232:235], v[92:95], v[196:199]
    v_fmac_f32 v218, v202, v210
    v_fmac_f32 v218, v203, v211
    v_mfma_f32_16x16x32_bf16 v[200:203], v[228:231], v[136:139], 0
    v_fmac_f32 v219, v204, v208
    v_fmac_f32 v219, v205, v209
    v_mfma_f32_16x16x32_bf16 v[200:203], v[232:235], v[140:143], v[200:203]
    v_fmac_f32 v219, v206, v210
    v_fmac_f32 v219, v207, v211
    s_waitcnt lgkmcnt(0)
    v_mfma_f32_16x16x32_bf16 v[204:207], v[228:231], v[184:187], 0
    v_fmac_f32 v216, v192, v212
    v_mfma_f32_16x16x32_bf16 v[204:207], v[232:235], v[188:191], v[204:207]
    ds_read_b128 v[208:211], v238 offset:15360
    v_mfma_f32_16x16x32_bf16 v[192:195], v[0:3], v[40:43], 0
    v_fmac_f32 v217, v197, v212
    v_mfma_f32_16x16x32_bf16 v[192:195], v[4:7], v[44:47], v[192:195]
    v_mfma_f32_16x16x32_bf16 v[196:199], v[48:51], v[88:91], 0
    v_fmac_f32 v218, v202, v212
    v_mfma_f32_16x16x32_bf16 v[196:199], v[52:55], v[92:95], v[196:199]
    s_nop 0
    v_mfma_f32_16x16x32_bf16 v[200:203], v[96:99], v[136:139], 0
    v_fmac_f32 v219, v207, v212
    v_mfma_f32_16x16x32_bf16 v[200:203], v[100:103], v[140:143], v[200:203]
    s_waitcnt lgkmcnt(0)
    v_mfma_f32_16x16x32_bf16 v[204:207], v[144:147], v[184:187], 0
    v_fmac_f32 v216, v192, v208
    v_fmac_f32 v216, v193, v209
    v_mfma_f32_16x16x32_bf16 v[204:207], v[148:151], v[188:191], v[204:207]
    v_fmac_f32 v216, v194, v210
    v_fmac_f32 v216, v195, v211
    ds_read_b128 v[212:215], v238 offset:16384
    v_mfma_f32_16x16x32_bf16 v[192:195], v[8:11], v[40:43], 0
    v_fmac_f32 v217, v196, v208
    v_fmac_f32 v217, v197, v209
    v_mfma_f32_16x16x32_bf16 v[192:195], v[12:15], v[44:47], v[192:195]
    v_fmac_f32 v217, v198, v210
    v_fmac_f32 v217, v199, v211
    v_mfma_f32_16x16x32_bf16 v[196:199], v[56:59], v[88:91], 0
    v_fmac_f32 v218, v200, v208
    v_fmac_f32 v218, v201, v209
    v_mfma_f32_16x16x32_bf16 v[196:199], v[60:63], v[92:95], v[196:199]
    v_fmac_f32 v218, v202, v210
    v_fmac_f32 v218, v203, v211
    v_mfma_f32_16x16x32_bf16 v[200:203], v[104:107], v[136:139], 0
    v_fmac_f32 v219, v204, v208
    v_fmac_f32 v219, v205, v209
    v_mfma_f32_16x16x32_bf16 v[200:203], v[108:111], v[140:143], v[200:203]
    v_fmac_f32 v219, v206, v210
    v_fmac_f32 v219, v207, v211
    s_waitcnt lgkmcnt(0)
    v_mfma_f32_16x16x32_bf16 v[204:207], v[152:155], v[184:187], 0
    v_fmac_f32 v216, v192, v212
    v_fmac_f32 v216, v193, v213
    v_mfma_f32_16x16x32_bf16 v[204:207], v[156:159], v[188:191], v[204:207]
    v_fmac_f32 v216, v194, v214
    v_fmac_f32 v216, v195, v215
    ds_read_b128 v[208:211], v238 offset:17408
    v_mfma_f32_16x16x32_bf16 v[192:195], v[16:19], v[40:43], 0
    v_fmac_f32 v217, v196, v212
    v_fmac_f32 v217, v197, v213
    v_mfma_f32_16x16x32_bf16 v[192:195], v[20:23], v[44:47], v[192:195]
    v_fmac_f32 v217, v198, v214
    v_fmac_f32 v217, v199, v215
    v_mfma_f32_16x16x32_bf16 v[196:199], v[64:67], v[88:91], 0
    v_fmac_f32 v218, v200, v212
    v_fmac_f32 v218, v201, v213
    v_mfma_f32_16x16x32_bf16 v[196:199], v[68:71], v[92:95], v[196:199]
    v_fmac_f32 v218, v202, v214
    v_fmac_f32 v218, v203, v215
    v_mfma_f32_16x16x32_bf16 v[200:203], v[112:115], v[136:139], 0
    v_fmac_f32 v219, v204, v212
    v_fmac_f32 v219, v205, v213
    v_mfma_f32_16x16x32_bf16 v[200:203], v[116:119], v[140:143], v[200:203]
    v_fmac_f32 v219, v206, v214
    v_fmac_f32 v219, v207, v215
    s_waitcnt lgkmcnt(0)
    v_mfma_f32_16x16x32_bf16 v[204:207], v[160:163], v[184:187], 0
    v_fmac_f32 v216, v192, v208
    v_fmac_f32 v216, v193, v209
    v_mfma_f32_16x16x32_bf16 v[204:207], v[164:167], v[188:191], v[204:207]
    v_fmac_f32 v216, v194, v210
    v_fmac_f32 v216, v195, v211
    ds_read_b128 v[212:215], v238 offset:18432
    v_mfma_f32_16x16x32_bf16 v[192:195], v[24:27], v[40:43], 0
    v_fmac_f32 v217, v196, v208
    v_fmac_f32 v217, v197, v209
    v_mfma_f32_16x16x32_bf16 v[192:195], v[28:31], v[44:47], v[192:195]
    v_fmac_f32 v217, v198, v210
    v_fmac_f32 v217, v199, v211
    v_mfma_f32_16x16x32_bf16 v[196:199], v[72:75], v[88:91], 0
    v_fmac_f32 v218, v200, v208
    v_fmac_f32 v218, v201, v209
    v_mfma_f32_16x16x32_bf16 v[196:199], v[76:79], v[92:95], v[196:199]
    v_fmac_f32 v218, v202, v210
    v_fmac_f32 v218, v203, v211
    v_mfma_f32_16x16x32_bf16 v[200:203], v[120:123], v[136:139], 0
    v_fmac_f32 v219, v204, v208
    v_fmac_f32 v219, v205, v209
    v_mfma_f32_16x16x32_bf16 v[200:203], v[124:127], v[140:143], v[200:203]
    v_fmac_f32 v219, v206, v210
    v_fmac_f32 v219, v207, v211
    s_waitcnt lgkmcnt(0)
    v_mfma_f32_16x16x32_bf16 v[204:207], v[168:171], v[184:187], 0
    v_fmac_f32 v216, v192, v212
    v_fmac_f32 v216, v193, v213
    v_mfma_f32_16x16x32_bf16 v[204:207], v[172:175], v[188:191], v[204:207]
    v_fmac_f32 v216, v194, v214
    v_fmac_f32 v216, v195, v215
    ds_read_b128 v[208:211], v238 offset:19456
    v_mfma_f32_16x16x32_bf16 v[192:195], v[32:35], v[40:43], 0
    v_fmac_f32 v217, v196, v212
    v_fmac_f32 v217, v197, v213
    v_mfma_f32_16x16x32_bf16 v[192:195], v[36:39], v[44:47], v[192:195]
    v_fmac_f32 v217, v198, v214
    v_fmac_f32 v217, v199, v215
    v_mfma_f32_16x16x32_bf16 v[196:199], v[80:83], v[88:91], 0
    v_fmac_f32 v218, v200, v212
    v_fmac_f32 v218, v201, v213
    v_mfma_f32_16x16x32_bf16 v[196:199], v[84:87], v[92:95], v[196:199]
    v_fmac_f32 v218, v202, v214
    v_fmac_f32 v218, v203, v215
    v_mfma_f32_16x16x32_bf16 v[200:203], v[128:131], v[136:139], 0
    v_fmac_f32 v219, v204, v212
    v_fmac_f32 v219, v205, v213
    v_mfma_f32_16x16x32_bf16 v[200:203], v[132:135], v[140:143], v[200:203]
    v_fmac_f32 v219, v206, v214
    v_fmac_f32 v219, v207, v215
    s_waitcnt lgkmcnt(0)
    v_mfma_f32_16x16x32_bf16 v[204:207], v[176:179], v[184:187], 0
    v_fmac_f32 v216, v192, v208
    v_fmac_f32 v216, v193, v209
    v_mfma_f32_16x16x32_bf16 v[204:207], v[180:183], v[188:191], v[204:207]
    v_fmac_f32 v216, v194, v210
    v_fmac_f32 v216, v195, v211
    ds_read_b128 v[212:215], v238 offset:20480
    v_mfma_f32_16x16x32_bf16 v[192:195], v[40:43], v[40:43], 0
    v_fmac_f32 v217, v196, v208
    v_fmac_f32 v217, v197, v209
    v_mfma_f32_16x16x32_bf16 v[192:195], v[44:47], v[44:47], v[192:195]
    v_fmac_f32 v217, v198, v210
    v_fmac_f32 v217, v199, v211
    v_mfma_f32_16x16x32_bf16 v[196:199], v[88:91], v[88:91], 0
    v_fmac_f32 v218, v200, v208
    v_fmac_f32 v218, v201, v209
    v_mfma_f32_16x16x32_bf16 v[196:199], v[92:95], v[92:95], v[196:199]
    v_fmac_f32 v218, v202, v210
    v_fmac_f32 v218, v203, v211
    v_mfma_f32_16x16x32_bf16 v[200:203], v[136:139], v[136:139], 0
    v_fmac_f32 v219, v204, v208
    v_fmac_f32 v219, v205, v209
    v_mfma_f32_16x16x32_bf16 v[200:203], v[140:143], v[140:143], v[200:203]
    v_fmac_f32 v219, v206, v210
    v_fmac_f32 v219, v207, v211
    s_waitcnt lgkmcnt(0)
    v_mfma_f32_16x16x32_bf16 v[204:207], v[184:187], v[184:187], 0
    v_fmac_f32 v216, v192, v212
    v_fmac_f32 v216, v193, v213
    v_mfma_f32_16x16x32_bf16 v[204:207], v[188:191], v[188:191], v[204:207]
    v_fmac_f32 v216, v194, v214
    v_fmac_f32 v216, v195, v215
    v_fmac_f32 v217, v196, v212
    v_fmac_f32 v217, v197, v213
    v_fmac_f32 v217, v198, v214
    v_fmac_f32 v217, v199, v215
    v_fmac_f32 v218, v200, v212
    v_fmac_f32 v218, v201, v213
    v_fmac_f32 v218, v202, v214
    v_fmac_f32 v218, v203, v215
    v_fmac_f32 v219, v204, v212
    v_fmac_f32 v219, v205, v213
    v_fmac_f32 v219, v206, v214
    v_fmac_f32 v219, v207, v215
    v_mbcnt_lo_u32_b32 v240, -1, 0
    v_mbcnt_hi_u32_b32 v240, -1, v240
    v_add_f32_dpp v216, v216, v216 row_shr:1 row_mask:0xf bank_mask:0xf bound_ctrl:1
    v_add_f32_dpp v217, v217, v217 row_shr:1 row_mask:0xf bank_mask:0xf bound_ctrl:1
    v_add_f32_dpp v218, v218, v218 row_shr:1 row_mask:0xf bank_mask:0xf bound_ctrl:1
    v_add_f32_dpp v219, v219, v219 row_shr:1 row_mask:0xf bank_mask:0xf bound_ctrl:1
    v_add_f32_dpp v216, v216, v216 row_shr:2 row_mask:0xf bank_mask:0xf bound_ctrl:1
    v_add_f32_dpp v217, v217, v217 row_shr:2 row_mask:0xf bank_mask:0xf bound_ctrl:1
    v_add_f32_dpp v218, v218, v218 row_shr:2 row_mask:0xf bank_mask:0xf bound_ctrl:1
    v_add_f32_dpp v219, v219, v219 row_shr:2 row_mask:0xf bank_mask:0xf bound_ctrl:1
    v_add_f32_dpp v216, v216, v216 row_shr:4 row_mask:0xf bank_mask:0xf bound_ctrl:1
    v_add_f32_dpp v217, v217, v217 row_shr:4 row_mask:0xf bank_mask:0xf bound_ctrl:1
    v_add_f32_dpp v218, v218, v218 row_shr:4 row_mask:0xf bank_mask:0xf bound_ctrl:1
    v_add_f32_dpp v219, v219, v219 row_shr:4 row_mask:0xf bank_mask:0xf bound_ctrl:1
    v_add_f32_dpp v216, v216, v216 row_shr:8 row_mask:0xf bank_mask:0xf bound_ctrl:1
    v_add_f32_dpp v217, v217, v217 row_shr:8 row_mask:0xf bank_mask:0xf bound_ctrl:1
    v_add_f32_dpp v218, v218, v218 row_shr:8 row_mask:0xf bank_mask:0xf bound_ctrl:1
    v_add_f32_dpp v219, v219, v219 row_shr:8 row_mask:0xf bank_mask:0xf bound_ctrl:1
    v_lshrrev_b32 v248, 4, v240
    v_lshlrev_b32 v248, 6, v248
    s_lshl_b32 s70, s69, 4
    s_add_u32 s70, s70, 133120
    v_add_u32 v248, s70, v248
    s_mov_b32 exec_lo, 0x80008000
    s_mov_b32 exec_hi, 0x80008000
    ds_write_b128 v248, v[216:219]
    s_mov_b64 exec, -1
    s_waitcnt lgkmcnt(0)
    s_barrier
    s_endpgm
Lnn__recsys_CSTART:
    s_setprio 2
    s_sub_u32 s72, s69, 4
    s_getpc_b64 s[76:77]
Lnn__recsys_PC:
    s_sub_u32 s76, s76, Lnn__recsys_PC-standalone__deep_cross_pnn__recsys_kernel
    s_subb_u32 s77, s77, 0
    s_lshr_b32 s70, s2, 3
    s_lshl_b32 s70, s70, 2
    s_add_u32 s70, s70, s72
    s_lshl_b32 s70, s70, 9
    v_lshlrev_b32 v240, 6, v250
    v_add_u32 v240, s70, v240
    v_min_u32 v240, Lnn__recsys_END-standalone__deep_cross_pnn__recsys_kernel, v240
    v_mov_b32 v241, s77
    v_add_co_u32 v240, vcc, s76, v240
    s_nop 1
    v_addc_co_u32 v241, vcc, 0, v241, vcc
    s_mov_b64 exec, 0xff
    global_load_dword v242, v[240:241], off
    s_mov_b64 exec, -1
    s_and_b32 s73, s72, 1
    s_lshr_b32 s74, s72, 1
    v_lshlrev_b32 v254, 4, v250
    s_mul_i32 s70, s72, 5120
    s_memrealtime s[96:97]
    s_waitcnt lgkmcnt(0)
    s_mov_b32 s36, s8
    s_mov_b32 s37, s9
    s_mov_b32 s38, 20000
    s_mov_b32 s39, 0x20000
    s_add_u32 m0, s70, 114688
    s_add_u32 s71, s70, 0
    buffer_load_dwordx4 v254, s[36:39], s71 offen lds
    s_add_u32 m0, s70, 115712
    s_add_u32 s71, s70, 1024
    buffer_load_dwordx4 v254, s[36:39], s71 offen lds
    s_add_u32 m0, s70, 116736
    s_add_u32 s71, s70, 2048
    buffer_load_dwordx4 v254, s[36:39], s71 offen lds
    s_add_u32 m0, s70, 117760
    s_add_u32 s71, s70, 3072
    buffer_load_dwordx4 v254, s[36:39], s71 offen lds
    s_add_u32 m0, s70, 118784
    s_add_u32 s71, s70, 4096
    buffer_load_dwordx4 v254, s[36:39], s71 offen lds
    s_mov_b32 s40, s22
    s_mov_b32 s41, s23
    s_mov_b32 s42, 16777216
    s_mov_b32 s43, 0x20000
    s_mov_b32 s44, s20
    s_mov_b32 s45, s21
    s_mov_b32 s46, 256
    s_mov_b32 s47, 0x20000
    s_mov_b32 s48, s12
    s_mov_b32 s49, s13
    s_mov_b32 s50, 512
    s_mov_b32 s51, 0x20000
    s_mov_b32 s52, s14
    s_mov_b32 s53, s15
    s_mov_b32 s54, 512
    s_mov_b32 s55, 0x20000
    v_lshrrev_b32 v248, 4, v250
    v_lshlrev_b32 v248, 3, v248
    s_lshl_b32 s71, s73, 1
    s_add_u32 s61, s71, s74
    s_lshl_b32 s71, s61, 7
    s_cmp_eq_u32 s73, s66
    s_cselect_b32 s62, s65, 99
    s_cmp_eq_u32 s65, 0
    s_cselect_b32 s50, 512, 0
    s_lshl_b32 s60, s66, 1
    s_add_u32 s60, s60, s74
    s_lshl_b32 s60, s60, 7
    buffer_load_dwordx2 v[176:177], v248, s[48:51], s60 offen offset:0
    buffer_load_dwordx2 v[178:179], v248, s[48:51], s60 offen offset:32
    buffer_load_dwordx2 v[180:181], v248, s[48:51], s60 offen offset:64
    buffer_load_dwordx2 v[182:183], v248, s[48:51], s60 offen offset:96
    buffer_load_dwordx2 v[224:225], v248, s[52:55], s71 offen offset:0
    buffer_load_dwordx2 v[226:227], v248, s[52:55], s71 offen offset:32
    buffer_load_dwordx2 v[228:229], v248, s[52:55], s71 offen offset:64
    buffer_load_dwordx2 v[230:231], v248, s[52:55], s71 offen offset:96
    v_and_b32 v140, 15, v250
    v_lshrrev_b32 v141, 4, v250
    v_bfe_u32 v142, v250, 1, 3
    v_xor_b32 v142, v141, v142
    v_lshlrev_b32 v142, 4, v142
    v_lshl_add_u32 v142, v140, 7, v142
    s_lshl_b32 s70, s73, 13
    v_add_u32 v128, s70, v142
    v_xor_b32 v129, 64, v128
    v_bfe_u32 v142, v250, 2, 2
    v_lshl_add_u32 v143, v141, 3, v142
    v_lshlrev_b32 v143, 8, v143
    v_bfe_u32 v144, v250, 1, 1
    s_lshl_b32 s70, s74, 3
    v_or_b32 v144, s70, v144
    v_lshlrev_b32 v142, 2, v142
    v_xor_b32 v144, v144, v142
    v_and_b32 v142, 1, v141
    v_lshlrev_b32 v142, 1, v142
    v_xor_b32 v144, v144, v142
    v_lshl_add_u32 v143, v144, 4, v143
    v_and_b32 v144, 1, v250
    v_lshl_add_u32 v143, v144, 3, v143
    v_xor_b32 v142, 0, v143
    v_add_u32 v130, 65536, v142
    v_xor_b32 v142, 32, v143
    v_add_u32 v131, 65536, v142
    v_xor_b32 v142, 64, v143
    v_add_u32 v132, 65536, v142
    v_xor_b32 v142, 96, v143
    v_add_u32 v133, 65536, v142
    v_lshlrev_b32 v134, 4, v250
    s_mov_b32 s76, 114688
    v_lshrrev_b32 v140, 4, v250
    v_bfe_u32 v141, v250, 2, 2
    v_and_b32 v142, 3, v250
    v_mul_u32_u24 v143, 24, v140
    v_add_u32 v143, v143, v141
    v_mul_u32_u24 v143, 200, v143
    v_mul_u32_u24 v144, 48, v142
    v_add3_u32 v145, v143, v144, s76
    v_mul_u32_u24 v143, 24, v141
    v_add_u32 v143, v143, v142
    v_mul_u32_u24 v144, 200, v143
    v_add_u32 v144, s76, v144
    v_lshl_add_u32 v151, v140, 1, v144
    v_mul_u32_u24 v146, 48, v140
    v_add_u32 v146, v146, v144
    v_mul_u32_u24 v144, 200, v140
    v_add_u32 v144, s76, v144
    v_lshl_add_u32 v147, v143, 1, v144
    v_lshl_add_u32 v153, v141, 1, v144
    v_add_u32 v148, 135168, v254
    v_lshlrev_b32 v149, 2, v250
    v_add_u32 v149, 157696, v149
    v_mov_b32 v48, 0
    v_mov_b32 v49, 0
    v_mov_b32 v50, 0
    v_mov_b32 v51, 0
    v_mov_b32 v52, 0
    v_mov_b32 v53, 0
    v_mov_b32 v54, 0
    v_mov_b32 v55, 0
    s_mov_b32 s75, 0xffff0000
    s_waitcnt vmcnt(8)
    s_barrier
    s_cmp_lg_u32 s72, 0
    s_cbranch_scc1 Lnn__recsys_WB1
    ds_read_b64_tr_b16 v[0:1], v145 offset:0
    ds_read_b64_tr_b16 v[4:5], v145 offset:8
    ds_read_b64 v[6:7], v146 offset:800
    ds_read_b64_tr_b16 v[8:9], v145 offset:16
    ds_read_b64 v[10:11], v146 offset:1600
    ds_read_b64_tr_b16 v[12:13], v145 offset:816
    ds_read_b64 v[14:15], v146 offset:1608
    ds_read_b64_tr_b16 v[16:17], v145 offset:24
    ds_read_b64 v[18:19], v146 offset:2400
    ds_read_b64_tr_b16 v[20:21], v145 offset:824
    ds_read_b64 v[22:23], v146 offset:2408
    s_waitcnt lgkmcnt(10)
    v_lshlrev_b32 v24, 16, v0
    v_and_b32 v25, s75, v0
    v_lshlrev_b32 v26, 16, v1
    v_and_b32 v27, s75, v1
    ds_write_b128 v148, v[24:27] offset:0
    s_waitcnt lgkmcnt(9)
    v_lshlrev_b32 v32, 16, v4
    v_and_b32 v33, s75, v4
    v_lshlrev_b32 v34, 16, v5
    v_and_b32 v35, s75, v5
    v_lshlrev_b32 v36, 16, v6
    v_and_b32 v37, s75, v6
    v_lshlrev_b32 v38, 16, v7
    v_and_b32 v39, s75, v7
    v_add_f32 v32, v32, v36
    v_add_f32 v33, v33, v37
    v_add_f32 v34, v34, v38
    v_add_f32 v35, v35, v39
    ds_write_b128 v148, v[32:35] offset:1024
    s_waitcnt lgkmcnt(8)
    v_lshlrev_b32 v40, 16, v8
    v_and_b32 v41, s75, v8
    v_lshlrev_b32 v42, 16, v9
    v_and_b32 v43, s75, v9
    v_lshlrev_b32 v44, 16, v10
    v_and_b32 v45, s75, v10
    v_lshlrev_b32 v46, 16, v11
    v_and_b32 v47, s75, v11
    v_add_f32 v40, v40, v44
    v_add_f32 v41, v41, v45
    v_add_f32 v42, v42, v46
    v_add_f32 v43, v43, v47
    ds_write_b128 v148, v[40:43] offset:3072
    s_waitcnt lgkmcnt(7)
    v_lshlrev_b32 v24, 16, v12
    v_and_b32 v25, s75, v12
    v_lshlrev_b32 v26, 16, v13
    v_and_b32 v27, s75, v13
    v_lshlrev_b32 v28, 16, v14
    v_and_b32 v29, s75, v14
    v_lshlrev_b32 v30, 16, v15
    v_and_b32 v31, s75, v15
    v_add_f32 v24, v24, v28
    v_add_f32 v25, v25, v29
    v_add_f32 v26, v26, v30
    v_add_f32 v27, v27, v31
    ds_write_b128 v148, v[24:27] offset:4096
    s_waitcnt lgkmcnt(6)
    v_lshlrev_b32 v32, 16, v16
    v_and_b32 v33, s75, v16
    v_lshlrev_b32 v34, 16, v17
    v_and_b32 v35, s75, v17
    v_lshlrev_b32 v36, 16, v18
    v_and_b32 v37, s75, v18
    v_lshlrev_b32 v38, 16, v19
    v_and_b32 v39, s75, v19
    v_add_f32 v32, v32, v36
    v_add_f32 v33, v33, v37
    v_add_f32 v34, v34, v38
    v_add_f32 v35, v35, v39
    ds_write_b128 v148, v[32:35] offset:6144
    s_waitcnt lgkmcnt(5)
    v_lshlrev_b32 v40, 16, v20
    v_and_b32 v41, s75, v20
    v_lshlrev_b32 v42, 16, v21
    v_and_b32 v43, s75, v21
    v_lshlrev_b32 v44, 16, v22
    v_and_b32 v45, s75, v22
    v_lshlrev_b32 v46, 16, v23
    v_and_b32 v47, s75, v23
    v_add_f32 v40, v40, v44
    v_add_f32 v41, v41, v45
    v_add_f32 v42, v42, v46
    v_add_f32 v43, v43, v47
    ds_write_b128 v148, v[40:43] offset:7168
    s_branch Lnn__recsys_WBDONE
Lnn__recsys_WB1:
    s_cmp_lg_u32 s72, 1
    s_cbranch_scc1 Lnn__recsys_WB2
    ds_read_b64_tr_b16 v[0:1], v145 offset:808
    ds_read_b64_tr_b16 v[4:5], v145 offset:1624
    ds_read_b64 v[6:7], v146 offset:2416
    ds_read_b64_tr_b16 v[8:9], v145 offset:32
    ds_read_b64 v[10:11], v146 offset:3200
    ds_read_b64_tr_b16 v[12:13], v145 offset:832
    ds_read_b64 v[14:15], v146 offset:3208
    ds_read_b64_tr_b16 v[16:17], v145 offset:1632
    ds_read_b64 v[18:19], v146 offset:3216
    ds_read_u16_d16_hi v48, v153 offset:19392
    s_waitcnt lgkmcnt(9)
    v_lshlrev_b32 v24, 16, v0
    v_and_b32 v25, s75, v0
    v_lshlrev_b32 v26, 16, v1
    v_and_b32 v27, s75, v1
    ds_write_b128 v148, v[24:27] offset:2048
    s_waitcnt lgkmcnt(8)
    v_lshlrev_b32 v32, 16, v4
    v_and_b32 v33, s75, v4
    v_lshlrev_b32 v34, 16, v5
    v_and_b32 v35, s75, v5
    v_lshlrev_b32 v36, 16, v6
    v_and_b32 v37, s75, v6
    v_lshlrev_b32 v38, 16, v7
    v_and_b32 v39, s75, v7
    v_add_f32 v32, v32, v36
    v_add_f32 v33, v33, v37
    v_add_f32 v34, v34, v38
    v_add_f32 v35, v35, v39
    ds_write_b128 v148, v[32:35] offset:8192
    s_waitcnt lgkmcnt(7)
    v_lshlrev_b32 v40, 16, v8
    v_and_b32 v41, s75, v8
    v_lshlrev_b32 v42, 16, v9
    v_and_b32 v43, s75, v9
    v_lshlrev_b32 v44, 16, v10
    v_and_b32 v45, s75, v10
    v_lshlrev_b32 v46, 16, v11
    v_and_b32 v47, s75, v11
    v_add_f32 v40, v40, v44
    v_add_f32 v41, v41, v45
    v_add_f32 v42, v42, v46
    v_add_f32 v43, v43, v47
    ds_write_b128 v148, v[40:43] offset:10240
    s_waitcnt lgkmcnt(6)
    v_lshlrev_b32 v24, 16, v12
    v_and_b32 v25, s75, v12
    v_lshlrev_b32 v26, 16, v13
    v_and_b32 v27, s75, v13
    v_lshlrev_b32 v28, 16, v14
    v_and_b32 v29, s75, v14
    v_lshlrev_b32 v30, 16, v15
    v_and_b32 v31, s75, v15
    v_add_f32 v24, v24, v28
    v_add_f32 v25, v25, v29
    v_add_f32 v26, v26, v30
    v_add_f32 v27, v27, v31
    ds_write_b128 v148, v[24:27] offset:11264
    s_waitcnt lgkmcnt(5)
    v_lshlrev_b32 v32, 16, v16
    v_and_b32 v33, s75, v16
    v_lshlrev_b32 v34, 16, v17
    v_and_b32 v35, s75, v17
    v_lshlrev_b32 v36, 16, v18
    v_and_b32 v37, s75, v18
    v_lshlrev_b32 v38, 16, v19
    v_and_b32 v39, s75, v19
    v_add_f32 v32, v32, v36
    v_add_f32 v33, v33, v37
    v_add_f32 v34, v34, v38
    v_add_f32 v35, v35, v39
    ds_write_b128 v148, v[32:35] offset:12288
    s_waitcnt lgkmcnt(5)
    s_mov_b32 vcc_lo, 0x11111111
    s_mov_b32 vcc_hi, 0x11111111
    v_cndmask_b32 v40, 0, v48, vcc
    s_mov_b32 vcc_lo, 0x22222222
    s_mov_b32 vcc_hi, 0x22222222
    v_cndmask_b32 v41, 0, v48, vcc
    s_mov_b32 vcc_lo, 0x44444444
    s_mov_b32 vcc_hi, 0x44444444
    v_cndmask_b32 v42, 0, v48, vcc
    s_mov_b32 vcc_lo, 0x88888888
    s_mov_b32 vcc_hi, 0x88888888
    v_cndmask_b32 v43, 0, v48, vcc
    ds_write_b128 v148, v[40:43] offset:21504
    s_branch Lnn__recsys_WBDONE
Lnn__recsys_WB2:
    s_cmp_lg_u32 s72, 2
    s_cbranch_scc1 Lnn__recsys_WB3
    ds_read_b64_tr_b16 v[0:1], v145 offset:1616
    ds_read_b64_tr_b16 v[4:5], v145 offset:2424
    ds_read_b64_tr_b16 v[8:9], v145 offset:2432
    ds_read_b64 v[10:11], v146 offset:3224
    ds_read_b64_tr_b16 v[12:13], v145 offset:40
    ds_read_b64 v[14:15], v146 offset:4000
    ds_read_b64_tr_b16 v[16:17], v145 offset:840
    ds_read_b64 v[18:19], v146 offset:4008
    ds_read_u16_d16_hi v48, v147 offset:19200
    ds_read_u16_d16_hi v49, v151 offset:192
    ds_read_u16_d16_hi v50, v147 offset:19216
    ds_read_u16_d16_hi v51, v151 offset:1792
    ds_read_u16_d16_hi v52, v147 offset:19232
    ds_read_u16_d16_hi v53, v151 offset:3392
    s_waitcnt lgkmcnt(13)
    v_lshlrev_b32 v24, 16, v0
    v_and_b32 v25, s75, v0
    v_lshlrev_b32 v26, 16, v1
    v_and_b32 v27, s75, v1
    ds_write_b128 v148, v[24:27] offset:5120
    s_waitcnt lgkmcnt(13)
    v_lshlrev_b32 v32, 16, v4
    v_and_b32 v33, s75, v4
    v_lshlrev_b32 v34, 16, v5
    v_and_b32 v35, s75, v5
    ds_write_b128 v148, v[32:35] offset:9216
    s_waitcnt lgkmcnt(12)
    v_lshlrev_b32 v40, 16, v8
    v_and_b32 v41, s75, v8
    v_lshlrev_b32 v42, 16, v9
    v_and_b32 v43, s75, v9
    v_lshlrev_b32 v44, 16, v10
    v_and_b32 v45, s75, v10
    v_lshlrev_b32 v46, 16, v11
    v_and_b32 v47, s75, v11
    v_add_f32 v40, v40, v44
    v_add_f32 v41, v41, v45
    v_add_f32 v42, v42, v46
    v_add_f32 v43, v43, v47
    ds_write_b128 v148, v[40:43] offset:13312
    s_waitcnt lgkmcnt(11)
    v_lshlrev_b32 v24, 16, v12
    v_and_b32 v25, s75, v12
    v_lshlrev_b32 v26, 16, v13
    v_and_b32 v27, s75, v13
    v_lshlrev_b32 v28, 16, v14
    v_and_b32 v29, s75, v14
    v_lshlrev_b32 v30, 16, v15
    v_and_b32 v31, s75, v15
    v_add_f32 v24, v24, v28
    v_add_f32 v25, v25, v29
    v_add_f32 v26, v26, v30
    v_add_f32 v27, v27, v31
    ds_write_b128 v148, v[24:27] offset:15360
    s_waitcnt lgkmcnt(10)
    v_lshlrev_b32 v32, 16, v16
    v_and_b32 v33, s75, v16
    v_lshlrev_b32 v34, 16, v17
    v_and_b32 v35, s75, v17
    v_lshlrev_b32 v36, 16, v18
    v_and_b32 v37, s75, v18
    v_lshlrev_b32 v38, 16, v19
    v_and_b32 v39, s75, v19
    v_add_f32 v32, v32, v36
    v_add_f32 v33, v33, v37
    v_add_f32 v34, v34, v38
    v_add_f32 v35, v35, v39
    ds_write_b128 v148, v[32:35] offset:16384
    s_waitcnt lgkmcnt(9)
    v_add_f32 v48, v48, v49
    ds_write_b32 v149, v48 offset:0
    s_waitcnt lgkmcnt(8)
    v_add_f32 v50, v50, v51
    ds_write_b32 v149, v50 offset:512
    s_waitcnt lgkmcnt(7)
    v_add_f32 v52, v52, v53
    ds_write_b32 v149, v52 offset:1024
    s_branch Lnn__recsys_WBDONE
Lnn__recsys_WB3:
    ds_read_b64_tr_b16 v[0:1], v145 offset:3232
    ds_read_b64_tr_b16 v[4:5], v145 offset:1640
    ds_read_b64 v[6:7], v146 offset:4016
    ds_read_b64_tr_b16 v[8:9], v145 offset:2440
    ds_read_b64 v[10:11], v146 offset:4024
    ds_read_b64_tr_b16 v[12:13], v145 offset:3240
    ds_read_b64 v[14:15], v146 offset:4032
    ds_read_b64_tr_b16 v[16:17], v145 offset:4040
    ds_read_u16_d16_hi v48, v147 offset:19208
    ds_read_u16_d16_hi v49, v151 offset:992
    ds_read_u16_d16_hi v50, v147 offset:19224
    ds_read_u16_d16_hi v51, v151 offset:2592
    ds_read_u16_d16_hi v52, v147 offset:19240
    ds_read_u16_d16_hi v53, v151 offset:4192
    s_waitcnt lgkmcnt(13)
    v_lshlrev_b32 v24, 16, v0
    v_and_b32 v25, s75, v0
    v_lshlrev_b32 v26, 16, v1
    v_and_b32 v27, s75, v1
    ds_write_b128 v148, v[24:27] offset:14336
    s_waitcnt lgkmcnt(12)
    v_lshlrev_b32 v32, 16, v4
    v_and_b32 v33, s75, v4
    v_lshlrev_b32 v34, 16, v5
    v_and_b32 v35, s75, v5
    v_lshlrev_b32 v36, 16, v6
    v_and_b32 v37, s75, v6
    v_lshlrev_b32 v38, 16, v7
    v_and_b32 v39, s75, v7
    v_add_f32 v32, v32, v36
    v_add_f32 v33, v33, v37
    v_add_f32 v34, v34, v38
    v_add_f32 v35, v35, v39
    ds_write_b128 v148, v[32:35] offset:17408
    s_waitcnt lgkmcnt(11)
    v_lshlrev_b32 v40, 16, v8
    v_and_b32 v41, s75, v8
    v_lshlrev_b32 v42, 16, v9
    v_and_b32 v43, s75, v9
    v_lshlrev_b32 v44, 16, v10
    v_and_b32 v45, s75, v10
    v_lshlrev_b32 v46, 16, v11
    v_and_b32 v47, s75, v11
    v_add_f32 v40, v40, v44
    v_add_f32 v41, v41, v45
    v_add_f32 v42, v42, v46
    v_add_f32 v43, v43, v47
    ds_write_b128 v148, v[40:43] offset:18432
    s_waitcnt lgkmcnt(10)
    v_lshlrev_b32 v24, 16, v12
    v_and_b32 v25, s75, v12
    v_lshlrev_b32 v26, 16, v13
    v_and_b32 v27, s75, v13
    v_lshlrev_b32 v28, 16, v14
    v_and_b32 v29, s75, v14
    v_lshlrev_b32 v30, 16, v15
    v_and_b32 v31, s75, v15
    v_add_f32 v24, v24, v28
    v_add_f32 v25, v25, v29
    v_add_f32 v26, v26, v30
    v_add_f32 v27, v27, v31
    ds_write_b128 v148, v[24:27] offset:19456
    s_waitcnt lgkmcnt(10)
    v_lshlrev_b32 v32, 16, v16
    v_and_b32 v33, s75, v16
    v_lshlrev_b32 v34, 16, v17
    v_and_b32 v35, s75, v17
    ds_write_b128 v148, v[32:35] offset:20480
    s_waitcnt lgkmcnt(9)
    v_add_f32 v48, v48, v49
    ds_write_b32 v149, v48 offset:256
    s_waitcnt lgkmcnt(8)
    v_add_f32 v50, v50, v51
    ds_write_b32 v149, v50 offset:768
    s_waitcnt lgkmcnt(7)
    v_add_f32 v52, v52, v53
    ds_write_b32 v149, v52 offset:1280
Lnn__recsys_WBDONE:
    s_waitcnt vmcnt(0)
    v_lshlrev_b32 v160, 16, v176
    v_and_b32 v161, s75, v176
    v_lshlrev_b32 v162, 16, v177
    v_and_b32 v163, s75, v177
    v_lshlrev_b32 v164, 16, v178
    v_and_b32 v165, s75, v178
    v_lshlrev_b32 v166, 16, v179
    v_and_b32 v167, s75, v179
    v_lshlrev_b32 v168, 16, v180
    v_and_b32 v169, s75, v180
    v_lshlrev_b32 v170, 16, v181
    v_and_b32 v171, s75, v181
    v_lshlrev_b32 v172, 16, v182
    v_and_b32 v173, s75, v182
    v_lshlrev_b32 v174, 16, v183
    v_and_b32 v175, s75, v183
    v_and_b32 v140, 1, v250
    v_lshlrev_b32 v140, 4, v140
    v_mov_b32 v141, 0x3f80
    v_lshlrev_b32 v140, v140, v141
    v_bfe_u32 v141, v250, 1, 3
    v_lshrrev_b32 v142, 4, v250
    v_lshlrev_b32 v142, 1, v142
    v_cmp_eq_u32 vcc, v141, v142
    v_add_u32 v142, 1, v142
    v_mov_b32 v242, 0
    v_mov_b32 v243, 0
    v_cndmask_b32 v240, 0, v140, vcc
    v_cmp_eq_u32 vcc, v141, v142
    v_mov_b32 v244, v240
    s_nop 1
    v_cndmask_b32 v241, 0, v140, vcc
    v_mov_b32 v245, v241
    v_mov_b32 v232, 0xbdd2d3e8
    v_mov_b32 v233, 0xc0135761
    v_mov_b32 v234, 1.0
    v_mov_b32 v235, 1.0
    v_and_b32 v236, 15, v250
    v_lshlrev_b32 v236, 2, v236
    v_add_u32 v236, 132864, v236
    s_lshl_b32 s70, s72, 6
    v_add_u32 v237, s70, v236
    v_lshlrev_b32 v238, 1, v250
    s_waitcnt lgkmcnt(0)
    s_barrier
    ds_read_b128 v[64:67], v128 offset:0
    ds_read_b64_tr_b16 v[80:81], v130 offset:0
    ds_read_b64_tr_b16 v[82:83], v130 offset:1024
    ds_read_b128 v[68:71], v128 offset:2048
    ds_read_b64_tr_b16 v[84:85], v131 offset:0
    ds_read_b64_tr_b16 v[86:87], v131 offset:1024
    ds_read_b128 v[72:75], v128 offset:4096
    ds_read_b64_tr_b16 v[88:89], v132 offset:0
    ds_read_b64_tr_b16 v[90:91], v132 offset:1024
    ds_read_b128 v[76:79], v128 offset:6144
    ds_read_b64_tr_b16 v[92:93], v133 offset:0
    ds_read_b64_tr_b16 v[94:95], v133 offset:1024
    s_waitcnt lgkmcnt(0)
    v_mfma_f32_16x16x32_bf16 v[0:3], v[80:83], v[64:67], v[160:163]
    ds_read_b128 v[96:99], v129 offset:0
    v_mfma_f32_16x16x32_bf16 v[16:19], v[80:83], v[68:71], v[160:163]
    ds_read_b64_tr_b16 v[112:113], v130 offset:8192
    v_mfma_f32_16x16x32_bf16 v[4:7], v[84:87], v[64:67], v[164:167]
    ds_read_b64_tr_b16 v[114:115], v130 offset:9216
    v_mfma_f32_16x16x32_bf16 v[20:23], v[84:87], v[68:71], v[164:167]
    ds_read_b128 v[100:103], v129 offset:2048
    v_mfma_f32_16x16x32_bf16 v[32:35], v[80:83], v[72:75], v[160:163]
    ds_read_b64_tr_b16 v[116:117], v131 offset:8192
    v_mfma_f32_16x16x32_bf16 v[36:39], v[84:87], v[72:75], v[164:167]
    ds_read_b64_tr_b16 v[118:119], v131 offset:9216
    v_mfma_f32_16x16x32_bf16 v[8:11], v[88:91], v[64:67], v[168:171]
    ds_read_b128 v[104:107], v129 offset:4096
    v_mfma_f32_16x16x32_bf16 v[24:27], v[88:91], v[68:71], v[168:171]
    ds_read_b64_tr_b16 v[120:121], v132 offset:8192
    v_mfma_f32_16x16x32_bf16 v[40:43], v[88:91], v[72:75], v[168:171]
    ds_read_b64_tr_b16 v[122:123], v132 offset:9216
    v_mfma_f32_16x16x32_bf16 v[48:51], v[80:83], v[76:79], v[160:163]
    ds_read_b128 v[108:111], v129 offset:6144
    v_mfma_f32_16x16x32_bf16 v[52:55], v[84:87], v[76:79], v[164:167]
    ds_read_b64_tr_b16 v[124:125], v133 offset:8192
    v_mfma_f32_16x16x32_bf16 v[56:59], v[88:91], v[76:79], v[168:171]
    ds_read_b64_tr_b16 v[126:127], v133 offset:9216
    v_mfma_f32_16x16x32_bf16 v[12:15], v[92:95], v[64:67], v[172:175]
    v_mfma_f32_16x16x32_bf16 v[28:31], v[92:95], v[68:71], v[172:175]
    v_mfma_f32_16x16x32_bf16 v[44:47], v[92:95], v[72:75], v[172:175]
    v_mfma_f32_16x16x32_bf16 v[60:63], v[92:95], v[76:79], v[172:175]
    s_waitcnt lgkmcnt(0)
    s_barrier
    v_mfma_f32_16x16x32_bf16 v[0:3], v[112:115], v[96:99], v[0:3]
    ds_read_b128 v[64:67], v128 offset:16384
    v_mfma_f32_16x16x32_bf16 v[16:19], v[112:115], v[100:103], v[16:19]
    ds_read_b64_tr_b16 v[80:81], v130 offset:16384
    v_mfma_f32_16x16x32_bf16 v[4:7], v[116:119], v[96:99], v[4:7]
    ds_read_b64_tr_b16 v[82:83], v130 offset:17408
    v_mfma_f32_16x16x32_bf16 v[20:23], v[116:119], v[100:103], v[20:23]
    ds_read_b128 v[68:71], v128 offset:18432
    v_mfma_f32_16x16x32_bf16 v[32:35], v[112:115], v[104:107], v[32:35]
    ds_read_b64_tr_b16 v[84:85], v131 offset:16384
    v_mfma_f32_16x16x32_bf16 v[36:39], v[116:119], v[104:107], v[36:39]
    ds_read_b64_tr_b16 v[86:87], v131 offset:17408
    v_mfma_f32_16x16x32_bf16 v[8:11], v[120:123], v[96:99], v[8:11]
    ds_read_b128 v[72:75], v128 offset:20480
    v_mfma_f32_16x16x32_bf16 v[24:27], v[120:123], v[100:103], v[24:27]
    ds_read_b64_tr_b16 v[88:89], v132 offset:16384
    v_mfma_f32_16x16x32_bf16 v[40:43], v[120:123], v[104:107], v[40:43]
    ds_read_b64_tr_b16 v[90:91], v132 offset:17408
    v_mfma_f32_16x16x32_bf16 v[48:51], v[112:115], v[108:111], v[48:51]
    ds_read_b128 v[76:79], v128 offset:22528
    v_mfma_f32_16x16x32_bf16 v[52:55], v[116:119], v[108:111], v[52:55]
    ds_read_b64_tr_b16 v[92:93], v133 offset:16384
    v_mfma_f32_16x16x32_bf16 v[56:59], v[120:123], v[108:111], v[56:59]
    ds_read_b64_tr_b16 v[94:95], v133 offset:17408
    v_mfma_f32_16x16x32_bf16 v[12:15], v[124:127], v[96:99], v[12:15]
    v_mfma_f32_16x16x32_bf16 v[28:31], v[124:127], v[100:103], v[28:31]
    v_mfma_f32_16x16x32_bf16 v[44:47], v[124:127], v[104:107], v[44:47]
    v_mfma_f32_16x16x32_bf16 v[60:63], v[124:127], v[108:111], v[60:63]
    s_or_b32 s70, s72, s67
    s_cmp_lg_u32 s70, 0
    s_cbranch_scc1 Lnn__recsys_NOLEAD
    s_lshl_b32 s70, s64, 2
    s_or_b32 s96, s96, 1
    v_mov_b32 v150, s96
    s_mov_b64 exec, 1
    buffer_store_dword v150, off, s[44:47], s70 offset:128 sc0 sc1
    s_mov_b64 exec, -1
Lnn__recsys_NOLEAD:
    s_waitcnt lgkmcnt(0)
    v_mfma_f32_16x16x32_bf16 v[0:3], v[80:83], v[64:67], v[0:3]
    ds_read_b128 v[96:99], v129 offset:16384
    v_mfma_f32_16x16x32_bf16 v[16:19], v[80:83], v[68:71], v[16:19]
    ds_read_b64_tr_b16 v[112:113], v130 offset:24576
    v_mfma_f32_16x16x32_bf16 v[4:7], v[84:87], v[64:67], v[4:7]
    ds_read_b64_tr_b16 v[114:115], v130 offset:25600
    v_mfma_f32_16x16x32_bf16 v[20:23], v[84:87], v[68:71], v[20:23]
    ds_read_b128 v[100:103], v129 offset:18432
    v_mfma_f32_16x16x32_bf16 v[32:35], v[80:83], v[72:75], v[32:35]
    ds_read_b64_tr_b16 v[116:117], v131 offset:24576
    v_mfma_f32_16x16x32_bf16 v[36:39], v[84:87], v[72:75], v[36:39]
    ds_read_b64_tr_b16 v[118:119], v131 offset:25600
    v_mfma_f32_16x16x32_bf16 v[8:11], v[88:91], v[64:67], v[8:11]
    ds_read_b128 v[104:107], v129 offset:20480
    v_mfma_f32_16x16x32_bf16 v[24:27], v[88:91], v[68:71], v[24:27]
    ds_read_b64_tr_b16 v[120:121], v132 offset:24576
    v_mfma_f32_16x16x32_bf16 v[40:43], v[88:91], v[72:75], v[40:43]
    ds_read_b64_tr_b16 v[122:123], v132 offset:25600
    v_mfma_f32_16x16x32_bf16 v[48:51], v[80:83], v[76:79], v[48:51]
    ds_read_b128 v[108:111], v129 offset:22528
    v_mfma_f32_16x16x32_bf16 v[52:55], v[84:87], v[76:79], v[52:55]
    ds_read_b64_tr_b16 v[124:125], v133 offset:24576
    v_mfma_f32_16x16x32_bf16 v[56:59], v[88:91], v[76:79], v[56:59]
    ds_read_b64_tr_b16 v[126:127], v133 offset:25600
    v_mfma_f32_16x16x32_bf16 v[12:15], v[92:95], v[64:67], v[12:15]
    v_mfma_f32_16x16x32_bf16 v[28:31], v[92:95], v[68:71], v[28:31]
    v_mfma_f32_16x16x32_bf16 v[44:47], v[92:95], v[72:75], v[44:47]
    v_mfma_f32_16x16x32_bf16 v[60:63], v[92:95], v[76:79], v[60:63]
    s_waitcnt lgkmcnt(0)
    s_barrier
    v_mfma_f32_16x16x32_bf16 v[0:3], v[112:115], v[96:99], v[0:3]
    ds_read_b128 v[64:67], v128 offset:32768
    v_mfma_f32_16x16x32_bf16 v[16:19], v[112:115], v[100:103], v[16:19]
    ds_read_b64_tr_b16 v[80:81], v130 offset:32768
    v_mfma_f32_16x16x32_bf16 v[4:7], v[116:119], v[96:99], v[4:7]
    ds_read_b64_tr_b16 v[82:83], v130 offset:33792
    v_mfma_f32_16x16x32_bf16 v[20:23], v[116:119], v[100:103], v[20:23]
    ds_read_b128 v[68:71], v128 offset:34816
    v_mfma_f32_16x16x32_bf16 v[32:35], v[112:115], v[104:107], v[32:35]
    ds_read_b64_tr_b16 v[84:85], v131 offset:32768
    v_mfma_f32_16x16x32_bf16 v[36:39], v[116:119], v[104:107], v[36:39]
    ds_read_b64_tr_b16 v[86:87], v131 offset:33792
    v_mfma_f32_16x16x32_bf16 v[8:11], v[120:123], v[96:99], v[8:11]
    ds_read_b128 v[72:75], v128 offset:36864
    v_mfma_f32_16x16x32_bf16 v[24:27], v[120:123], v[100:103], v[24:27]
    ds_read_b64_tr_b16 v[88:89], v132 offset:32768
    v_mfma_f32_16x16x32_bf16 v[40:43], v[120:123], v[104:107], v[40:43]
    ds_read_b64_tr_b16 v[90:91], v132 offset:33792
    v_mfma_f32_16x16x32_bf16 v[48:51], v[112:115], v[108:111], v[48:51]
    ds_read_b128 v[76:79], v128 offset:38912
    v_mfma_f32_16x16x32_bf16 v[52:55], v[116:119], v[108:111], v[52:55]
    ds_read_b64_tr_b16 v[92:93], v133 offset:32768
    v_mfma_f32_16x16x32_bf16 v[56:59], v[120:123], v[108:111], v[56:59]
    ds_read_b64_tr_b16 v[94:95], v133 offset:33792
    v_mfma_f32_16x16x32_bf16 v[12:15], v[124:127], v[96:99], v[12:15]
    v_mfma_f32_16x16x32_bf16 v[28:31], v[124:127], v[100:103], v[28:31]
    v_mfma_f32_16x16x32_bf16 v[44:47], v[124:127], v[104:107], v[44:47]
    v_mfma_f32_16x16x32_bf16 v[60:63], v[124:127], v[108:111], v[60:63]
    s_waitcnt lgkmcnt(0)
    v_mfma_f32_16x16x32_bf16 v[0:3], v[80:83], v[64:67], v[0:3]
    ds_read_b128 v[96:99], v129 offset:32768
    v_mfma_f32_16x16x32_bf16 v[16:19], v[80:83], v[68:71], v[16:19]
    ds_read_b64_tr_b16 v[112:113], v130 offset:40960
    v_mfma_f32_16x16x32_bf16 v[4:7], v[84:87], v[64:67], v[4:7]
    ds_read_b64_tr_b16 v[114:115], v130 offset:41984
    v_mfma_f32_16x16x32_bf16 v[20:23], v[84:87], v[68:71], v[20:23]
    ds_read_b128 v[100:103], v129 offset:34816
    v_mfma_f32_16x16x32_bf16 v[32:35], v[80:83], v[72:75], v[32:35]
    ds_read_b64_tr_b16 v[116:117], v131 offset:40960
    v_mfma_f32_16x16x32_bf16 v[36:39], v[84:87], v[72:75], v[36:39]
    ds_read_b64_tr_b16 v[118:119], v131 offset:41984
    v_mfma_f32_16x16x32_bf16 v[8:11], v[88:91], v[64:67], v[8:11]
    ds_read_b128 v[104:107], v129 offset:36864
    v_mfma_f32_16x16x32_bf16 v[24:27], v[88:91], v[68:71], v[24:27]
    ds_read_b64_tr_b16 v[120:121], v132 offset:40960
    v_mfma_f32_16x16x32_bf16 v[40:43], v[88:91], v[72:75], v[40:43]
    ds_read_b64_tr_b16 v[122:123], v132 offset:41984
    v_mfma_f32_16x16x32_bf16 v[48:51], v[80:83], v[76:79], v[48:51]
    ds_read_b128 v[108:111], v129 offset:38912
    v_mfma_f32_16x16x32_bf16 v[52:55], v[84:87], v[76:79], v[52:55]
    ds_read_b64_tr_b16 v[124:125], v133 offset:40960
    v_mfma_f32_16x16x32_bf16 v[56:59], v[88:91], v[76:79], v[56:59]
    ds_read_b64_tr_b16 v[126:127], v133 offset:41984
    v_mfma_f32_16x16x32_bf16 v[12:15], v[92:95], v[64:67], v[12:15]
    v_mfma_f32_16x16x32_bf16 v[28:31], v[92:95], v[68:71], v[28:31]
    v_mfma_f32_16x16x32_bf16 v[44:47], v[92:95], v[72:75], v[44:47]
    v_mfma_f32_16x16x32_bf16 v[60:63], v[92:95], v[76:79], v[60:63]
    s_waitcnt lgkmcnt(0)
    s_barrier
    v_mfma_f32_16x16x32_bf16 v[0:3], v[112:115], v[96:99], v[0:3]
    ds_read_b128 v[64:67], v128 offset:49152
    v_mfma_f32_16x16x32_bf16 v[16:19], v[112:115], v[100:103], v[16:19]
    ds_read_b64_tr_b16 v[80:81], v130 offset:49152
    v_mfma_f32_16x16x32_bf16 v[4:7], v[116:119], v[96:99], v[4:7]
    ds_read_b64_tr_b16 v[82:83], v130 offset:50176
    v_mfma_f32_16x16x32_bf16 v[20:23], v[116:119], v[100:103], v[20:23]
    ds_read_b128 v[68:71], v128 offset:51200
    v_mfma_f32_16x16x32_bf16 v[32:35], v[112:115], v[104:107], v[32:35]
    ds_read_b64_tr_b16 v[84:85], v131 offset:49152
    v_mfma_f32_16x16x32_bf16 v[36:39], v[116:119], v[104:107], v[36:39]
    ds_read_b64_tr_b16 v[86:87], v131 offset:50176
    v_mfma_f32_16x16x32_bf16 v[8:11], v[120:123], v[96:99], v[8:11]
    ds_read_b128 v[72:75], v128 offset:53248
    v_mfma_f32_16x16x32_bf16 v[24:27], v[120:123], v[100:103], v[24:27]
    ds_read_b64_tr_b16 v[88:89], v132 offset:49152
    v_mfma_f32_16x16x32_bf16 v[40:43], v[120:123], v[104:107], v[40:43]
    ds_read_b64_tr_b16 v[90:91], v132 offset:50176
    v_mfma_f32_16x16x32_bf16 v[48:51], v[112:115], v[108:111], v[48:51]
    ds_read_b128 v[76:79], v128 offset:55296
    v_mfma_f32_16x16x32_bf16 v[52:55], v[116:119], v[108:111], v[52:55]
    ds_read_b64_tr_b16 v[92:93], v133 offset:49152
    v_mfma_f32_16x16x32_bf16 v[56:59], v[120:123], v[108:111], v[56:59]
    ds_read_b64_tr_b16 v[94:95], v133 offset:50176
    v_mfma_f32_16x16x32_bf16 v[12:15], v[124:127], v[96:99], v[12:15]
    v_mfma_f32_16x16x32_bf16 v[28:31], v[124:127], v[100:103], v[28:31]
    v_mfma_f32_16x16x32_bf16 v[44:47], v[124:127], v[104:107], v[44:47]
    v_mfma_f32_16x16x32_bf16 v[60:63], v[124:127], v[108:111], v[60:63]
    s_waitcnt lgkmcnt(0)
    v_mfma_f32_16x16x32_bf16 v[0:3], v[80:83], v[64:67], v[0:3]
    ds_read_b128 v[96:99], v129 offset:49152
    v_mfma_f32_16x16x32_bf16 v[16:19], v[80:83], v[68:71], v[16:19]
    ds_read_b64_tr_b16 v[112:113], v130 offset:57344
    v_mfma_f32_16x16x32_bf16 v[4:7], v[84:87], v[64:67], v[4:7]
    ds_read_b64_tr_b16 v[114:115], v130 offset:58368
    v_mfma_f32_16x16x32_bf16 v[20:23], v[84:87], v[68:71], v[20:23]
    ds_read_b128 v[100:103], v129 offset:51200
    v_mfma_f32_16x16x32_bf16 v[32:35], v[80:83], v[72:75], v[32:35]
    ds_read_b64_tr_b16 v[116:117], v131 offset:57344
    v_mfma_f32_16x16x32_bf16 v[36:39], v[84:87], v[72:75], v[36:39]
    ds_read_b64_tr_b16 v[118:119], v131 offset:58368
    v_mfma_f32_16x16x32_bf16 v[8:11], v[88:91], v[64:67], v[8:11]
    ds_read_b128 v[104:107], v129 offset:53248
    v_mfma_f32_16x16x32_bf16 v[24:27], v[88:91], v[68:71], v[24:27]
    ds_read_b64_tr_b16 v[120:121], v132 offset:57344
    v_mfma_f32_16x16x32_bf16 v[40:43], v[88:91], v[72:75], v[40:43]
    ds_read_b64_tr_b16 v[122:123], v132 offset:58368
    v_mfma_f32_16x16x32_bf16 v[48:51], v[80:83], v[76:79], v[48:51]
    ds_read_b128 v[108:111], v129 offset:55296
    v_mfma_f32_16x16x32_bf16 v[52:55], v[84:87], v[76:79], v[52:55]
    ds_read_b64_tr_b16 v[124:125], v133 offset:57344
    v_mfma_f32_16x16x32_bf16 v[56:59], v[88:91], v[76:79], v[56:59]
    ds_read_b64_tr_b16 v[126:127], v133 offset:58368
    v_mfma_f32_16x16x32_bf16 v[12:15], v[92:95], v[64:67], v[12:15]
    v_mfma_f32_16x16x32_bf16 v[28:31], v[92:95], v[68:71], v[28:31]
    v_mfma_f32_16x16x32_bf16 v[44:47], v[92:95], v[72:75], v[44:47]
    v_mfma_f32_16x16x32_bf16 v[60:63], v[92:95], v[76:79], v[60:63]
    s_waitcnt lgkmcnt(0)
    s_barrier
    v_mfma_f32_16x16x32_bf16 v[0:3], v[112:115], v[96:99], v[0:3]
    ds_read_b128 v[64:67], v128 offset:0
    v_mfma_f32_16x16x32_bf16 v[16:19], v[112:115], v[100:103], v[16:19]
    ds_read_b64_tr_b16 v[80:81], v130 offset:0
    v_mfma_f32_16x16x32_bf16 v[4:7], v[116:119], v[96:99], v[4:7]
    ds_read_b64_tr_b16 v[82:83], v130 offset:1024
    v_mfma_f32_16x16x32_bf16 v[20:23], v[116:119], v[100:103], v[20:23]
    ds_read_b128 v[68:71], v128 offset:2048
    v_mfma_f32_16x16x32_bf16 v[32:35], v[112:115], v[104:107], v[32:35]
    ds_read_b64_tr_b16 v[84:85], v131 offset:0
    v_mfma_f32_16x16x32_bf16 v[36:39], v[116:119], v[104:107], v[36:39]
    ds_read_b64_tr_b16 v[86:87], v131 offset:1024
    v_mfma_f32_16x16x32_bf16 v[8:11], v[120:123], v[96:99], v[8:11]
    ds_read_b128 v[72:75], v128 offset:4096
    v_mfma_f32_16x16x32_bf16 v[24:27], v[120:123], v[100:103], v[24:27]
    ds_read_b64_tr_b16 v[88:89], v132 offset:0
    v_mfma_f32_16x16x32_bf16 v[40:43], v[120:123], v[104:107], v[40:43]
    ds_read_b64_tr_b16 v[90:91], v132 offset:1024
    v_mfma_f32_16x16x32_bf16 v[48:51], v[112:115], v[108:111], v[48:51]
    ds_read_b128 v[76:79], v128 offset:6144
    v_mfma_f32_16x16x32_bf16 v[52:55], v[116:119], v[108:111], v[52:55]
    ds_read_b64_tr_b16 v[92:93], v133 offset:0
    v_mfma_f32_16x16x32_bf16 v[56:59], v[120:123], v[108:111], v[56:59]
    ds_read_b64_tr_b16 v[94:95], v133 offset:1024
    v_mfma_f32_16x16x32_bf16 v[12:15], v[124:127], v[96:99], v[12:15]
    v_mfma_f32_16x16x32_bf16 v[28:31], v[124:127], v[100:103], v[28:31]
    v_mfma_f32_16x16x32_bf16 v[44:47], v[124:127], v[104:107], v[44:47]
    v_mfma_f32_16x16x32_bf16 v[60:63], v[124:127], v[108:111], v[60:63]
    s_waitcnt lgkmcnt(0)
    v_mfma_f32_16x16x32_bf16 v[0:3], v[80:83], v[64:67], v[0:3]
    ds_read_b128 v[96:99], v129 offset:0
    v_mfma_f32_16x16x32_bf16 v[16:19], v[80:83], v[68:71], v[16:19]
    ds_read_b64_tr_b16 v[112:113], v130 offset:8192
    v_mfma_f32_16x16x32_bf16 v[4:7], v[84:87], v[64:67], v[4:7]
    ds_read_b64_tr_b16 v[114:115], v130 offset:9216
    v_mfma_f32_16x16x32_bf16 v[20:23], v[84:87], v[68:71], v[20:23]
    ds_read_b128 v[100:103], v129 offset:2048
    v_mfma_f32_16x16x32_bf16 v[32:35], v[80:83], v[72:75], v[32:35]
    ds_read_b64_tr_b16 v[116:117], v131 offset:8192
    v_mfma_f32_16x16x32_bf16 v[36:39], v[84:87], v[72:75], v[36:39]
    ds_read_b64_tr_b16 v[118:119], v131 offset:9216
    v_mfma_f32_16x16x32_bf16 v[8:11], v[88:91], v[64:67], v[8:11]
    ds_read_b128 v[104:107], v129 offset:4096
    v_mfma_f32_16x16x32_bf16 v[24:27], v[88:91], v[68:71], v[24:27]
    ds_read_b64_tr_b16 v[120:121], v132 offset:8192
    v_mfma_f32_16x16x32_bf16 v[40:43], v[88:91], v[72:75], v[40:43]
    ds_read_b64_tr_b16 v[122:123], v132 offset:9216
    v_mfma_f32_16x16x32_bf16 v[48:51], v[80:83], v[76:79], v[48:51]
    ds_read_b128 v[108:111], v129 offset:6144
    v_mfma_f32_16x16x32_bf16 v[52:55], v[84:87], v[76:79], v[52:55]
    ds_read_b64_tr_b16 v[124:125], v133 offset:8192
    v_mfma_f32_16x16x32_bf16 v[56:59], v[88:91], v[76:79], v[56:59]
    ds_read_b64_tr_b16 v[126:127], v133 offset:9216
    v_mfma_f32_16x16x32_bf16 v[12:15], v[92:95], v[64:67], v[12:15]
    v_mfma_f32_16x16x32_bf16 v[28:31], v[92:95], v[68:71], v[28:31]
    v_mfma_f32_16x16x32_bf16 v[44:47], v[92:95], v[72:75], v[44:47]
    v_mfma_f32_16x16x32_bf16 v[60:63], v[92:95], v[76:79], v[60:63]
    s_waitcnt lgkmcnt(0)
    s_barrier
    v_mfma_f32_16x16x32_bf16 v[0:3], v[112:115], v[96:99], v[0:3]
    ds_read_b128 v[64:67], v128 offset:16384
    v_mfma_f32_16x16x32_bf16 v[16:19], v[112:115], v[100:103], v[16:19]
    ds_read_b64_tr_b16 v[80:81], v130 offset:16384
    v_mfma_f32_16x16x32_bf16 v[4:7], v[116:119], v[96:99], v[4:7]
    ds_read_b64_tr_b16 v[82:83], v130 offset:17408
    v_mfma_f32_16x16x32_bf16 v[20:23], v[116:119], v[100:103], v[20:23]
    ds_read_b128 v[68:71], v128 offset:18432
    v_mfma_f32_16x16x32_bf16 v[32:35], v[112:115], v[104:107], v[32:35]
    ds_read_b64_tr_b16 v[84:85], v131 offset:16384
    v_mfma_f32_16x16x32_bf16 v[36:39], v[116:119], v[104:107], v[36:39]
    ds_read_b64_tr_b16 v[86:87], v131 offset:17408
    v_mfma_f32_16x16x32_bf16 v[8:11], v[120:123], v[96:99], v[8:11]
    ds_read_b128 v[72:75], v128 offset:20480
    v_mfma_f32_16x16x32_bf16 v[24:27], v[120:123], v[100:103], v[24:27]
    ds_read_b64_tr_b16 v[88:89], v132 offset:16384
    v_mfma_f32_16x16x32_bf16 v[40:43], v[120:123], v[104:107], v[40:43]
    ds_read_b64_tr_b16 v[90:91], v132 offset:17408
    v_mfma_f32_16x16x32_bf16 v[48:51], v[112:115], v[108:111], v[48:51]
    ds_read_b128 v[76:79], v128 offset:22528
    v_mfma_f32_16x16x32_bf16 v[52:55], v[116:119], v[108:111], v[52:55]
    ds_read_b64_tr_b16 v[92:93], v133 offset:16384
    v_mfma_f32_16x16x32_bf16 v[56:59], v[120:123], v[108:111], v[56:59]
    ds_read_b64_tr_b16 v[94:95], v133 offset:17408
    v_mfma_f32_16x16x32_bf16 v[12:15], v[124:127], v[96:99], v[12:15]
    v_mfma_f32_16x16x32_bf16 v[28:31], v[124:127], v[100:103], v[28:31]
    v_mfma_f32_16x16x32_bf16 v[44:47], v[124:127], v[104:107], v[44:47]
    v_mfma_f32_16x16x32_bf16 v[60:63], v[124:127], v[108:111], v[60:63]
    s_waitcnt lgkmcnt(0)
    v_mfma_f32_16x16x32_bf16 v[0:3], v[80:83], v[64:67], v[0:3]
    ds_read_b128 v[96:99], v129 offset:16384
    v_mfma_f32_16x16x32_bf16 v[16:19], v[80:83], v[68:71], v[16:19]
    ds_read_b64_tr_b16 v[112:113], v130 offset:24576
    v_mfma_f32_16x16x32_bf16 v[4:7], v[84:87], v[64:67], v[4:7]
    ds_read_b64_tr_b16 v[114:115], v130 offset:25600
    v_mfma_f32_16x16x32_bf16 v[20:23], v[84:87], v[68:71], v[20:23]
    ds_read_b128 v[100:103], v129 offset:18432
    v_mfma_f32_16x16x32_bf16 v[32:35], v[80:83], v[72:75], v[32:35]
    ds_read_b64_tr_b16 v[116:117], v131 offset:24576
    v_mfma_f32_16x16x32_bf16 v[36:39], v[84:87], v[72:75], v[36:39]
    ds_read_b64_tr_b16 v[118:119], v131 offset:25600
    v_mfma_f32_16x16x32_bf16 v[8:11], v[88:91], v[64:67], v[8:11]
    ds_read_b128 v[104:107], v129 offset:20480
    v_mfma_f32_16x16x32_bf16 v[24:27], v[88:91], v[68:71], v[24:27]
    ds_read_b64_tr_b16 v[120:121], v132 offset:24576
    v_mfma_f32_16x16x32_bf16 v[40:43], v[88:91], v[72:75], v[40:43]
    ds_read_b64_tr_b16 v[122:123], v132 offset:25600
    v_mfma_f32_16x16x32_bf16 v[48:51], v[80:83], v[76:79], v[48:51]
    ds_read_b128 v[108:111], v129 offset:22528
    v_mfma_f32_16x16x32_bf16 v[52:55], v[84:87], v[76:79], v[52:55]
    ds_read_b64_tr_b16 v[124:125], v133 offset:24576
    v_mfma_f32_16x16x32_bf16 v[56:59], v[88:91], v[76:79], v[56:59]
    ds_read_b64_tr_b16 v[126:127], v133 offset:25600
    v_mfma_f32_16x16x32_bf16 v[12:15], v[92:95], v[64:67], v[12:15]
    v_mfma_f32_16x16x32_bf16 v[28:31], v[92:95], v[68:71], v[28:31]
    v_mfma_f32_16x16x32_bf16 v[44:47], v[92:95], v[72:75], v[44:47]
    v_mfma_f32_16x16x32_bf16 v[60:63], v[92:95], v[76:79], v[60:63]
    s_waitcnt lgkmcnt(0)
    s_barrier
    v_mfma_f32_16x16x32_bf16 v[0:3], v[112:115], v[96:99], v[0:3]
    ds_read_b128 v[64:67], v128 offset:32768
    v_mfma_f32_16x16x32_bf16 v[16:19], v[112:115], v[100:103], v[16:19]
    ds_read_b64_tr_b16 v[80:81], v130 offset:32768
    v_mfma_f32_16x16x32_bf16 v[4:7], v[116:119], v[96:99], v[4:7]
    ds_read_b64_tr_b16 v[82:83], v130 offset:33792
    v_mfma_f32_16x16x32_bf16 v[20:23], v[116:119], v[100:103], v[20:23]
    ds_read_b128 v[68:71], v128 offset:34816
    v_mfma_f32_16x16x32_bf16 v[32:35], v[112:115], v[104:107], v[32:35]
    ds_read_b64_tr_b16 v[84:85], v131 offset:32768
    v_mfma_f32_16x16x32_bf16 v[36:39], v[116:119], v[104:107], v[36:39]
    ds_read_b64_tr_b16 v[86:87], v131 offset:33792
    v_mfma_f32_16x16x32_bf16 v[8:11], v[120:123], v[96:99], v[8:11]
    ds_read_b128 v[72:75], v128 offset:36864
    v_mfma_f32_16x16x32_bf16 v[24:27], v[120:123], v[100:103], v[24:27]
    ds_read_b64_tr_b16 v[88:89], v132 offset:32768
    v_mfma_f32_16x16x32_bf16 v[40:43], v[120:123], v[104:107], v[40:43]
    ds_read_b64_tr_b16 v[90:91], v132 offset:33792
    v_mfma_f32_16x16x32_bf16 v[48:51], v[112:115], v[108:111], v[48:51]
    ds_read_b128 v[76:79], v128 offset:38912
    v_mfma_f32_16x16x32_bf16 v[52:55], v[116:119], v[108:111], v[52:55]
    ds_read_b64_tr_b16 v[92:93], v133 offset:32768
    v_mfma_f32_16x16x32_bf16 v[56:59], v[120:123], v[108:111], v[56:59]
    ds_read_b64_tr_b16 v[94:95], v133 offset:33792
    v_mfma_f32_16x16x32_bf16 v[12:15], v[124:127], v[96:99], v[12:15]
    v_mfma_f32_16x16x32_bf16 v[28:31], v[124:127], v[100:103], v[28:31]
    v_mfma_f32_16x16x32_bf16 v[44:47], v[124:127], v[104:107], v[44:47]
    v_mfma_f32_16x16x32_bf16 v[60:63], v[124:127], v[108:111], v[60:63]
    s_waitcnt lgkmcnt(0)
    v_mfma_f32_16x16x32_bf16 v[0:3], v[80:83], v[64:67], v[0:3]
    ds_read_b128 v[96:99], v129 offset:32768
    v_mfma_f32_16x16x32_bf16 v[16:19], v[80:83], v[68:71], v[16:19]
    ds_read_b64_tr_b16 v[112:113], v130 offset:40960
    v_mfma_f32_16x16x32_bf16 v[4:7], v[84:87], v[64:67], v[4:7]
    ds_read_b64_tr_b16 v[114:115], v130 offset:41984
    v_mfma_f32_16x16x32_bf16 v[20:23], v[84:87], v[68:71], v[20:23]
    ds_read_b128 v[100:103], v129 offset:34816
    v_mfma_f32_16x16x32_bf16 v[32:35], v[80:83], v[72:75], v[32:35]
    ds_read_b64_tr_b16 v[116:117], v131 offset:40960
    v_mfma_f32_16x16x32_bf16 v[36:39], v[84:87], v[72:75], v[36:39]
    ds_read_b64_tr_b16 v[118:119], v131 offset:41984
    v_mfma_f32_16x16x32_bf16 v[8:11], v[88:91], v[64:67], v[8:11]
    ds_read_b128 v[104:107], v129 offset:36864
    v_mfma_f32_16x16x32_bf16 v[24:27], v[88:91], v[68:71], v[24:27]
    ds_read_b64_tr_b16 v[120:121], v132 offset:40960
    v_mfma_f32_16x16x32_bf16 v[40:43], v[88:91], v[72:75], v[40:43]
    ds_read_b64_tr_b16 v[122:123], v132 offset:41984
    v_mfma_f32_16x16x32_bf16 v[48:51], v[80:83], v[76:79], v[48:51]
    ds_read_b128 v[108:111], v129 offset:38912
    v_mfma_f32_16x16x32_bf16 v[52:55], v[84:87], v[76:79], v[52:55]
    ds_read_b64_tr_b16 v[124:125], v133 offset:40960
    v_mfma_f32_16x16x32_bf16 v[56:59], v[88:91], v[76:79], v[56:59]
    ds_read_b64_tr_b16 v[126:127], v133 offset:41984
    v_mfma_f32_16x16x32_bf16 v[12:15], v[92:95], v[64:67], v[12:15]
    v_mfma_f32_16x16x32_bf16 v[28:31], v[92:95], v[68:71], v[28:31]
    v_mfma_f32_16x16x32_bf16 v[44:47], v[92:95], v[72:75], v[44:47]
    v_mfma_f32_16x16x32_bf16 v[60:63], v[92:95], v[76:79], v[60:63]
    s_waitcnt lgkmcnt(0)
    s_barrier
    v_mfma_f32_16x16x32_bf16 v[0:3], v[112:115], v[96:99], v[0:3]
    ds_read_b128 v[64:67], v128 offset:49152
    v_mfma_f32_16x16x32_bf16 v[16:19], v[112:115], v[100:103], v[16:19]
    ds_read_b64_tr_b16 v[80:81], v130 offset:49152
    v_mfma_f32_16x16x32_bf16 v[4:7], v[116:119], v[96:99], v[4:7]
    ds_read_b64_tr_b16 v[82:83], v130 offset:50176
    v_mfma_f32_16x16x32_bf16 v[20:23], v[116:119], v[100:103], v[20:23]
    ds_read_b128 v[68:71], v128 offset:51200
    v_mfma_f32_16x16x32_bf16 v[32:35], v[112:115], v[104:107], v[32:35]
    ds_read_b64_tr_b16 v[84:85], v131 offset:49152
    v_mfma_f32_16x16x32_bf16 v[36:39], v[116:119], v[104:107], v[36:39]
    ds_read_b64_tr_b16 v[86:87], v131 offset:50176
    v_mfma_f32_16x16x32_bf16 v[8:11], v[120:123], v[96:99], v[8:11]
    ds_read_b128 v[72:75], v128 offset:53248
    v_mfma_f32_16x16x32_bf16 v[24:27], v[120:123], v[100:103], v[24:27]
    ds_read_b64_tr_b16 v[88:89], v132 offset:49152
    v_mfma_f32_16x16x32_bf16 v[40:43], v[120:123], v[104:107], v[40:43]
    ds_read_b64_tr_b16 v[90:91], v132 offset:50176
    v_mfma_f32_16x16x32_bf16 v[48:51], v[112:115], v[108:111], v[48:51]
    ds_read_b128 v[76:79], v128 offset:55296
    v_mfma_f32_16x16x32_bf16 v[52:55], v[116:119], v[108:111], v[52:55]
    ds_read_b64_tr_b16 v[92:93], v133 offset:49152
    v_mfma_f32_16x16x32_bf16 v[56:59], v[120:123], v[108:111], v[56:59]
    ds_read_b64_tr_b16 v[94:95], v133 offset:50176
    v_mfma_f32_16x16x32_bf16 v[12:15], v[124:127], v[96:99], v[12:15]
    v_mfma_f32_16x16x32_bf16 v[28:31], v[124:127], v[100:103], v[28:31]
    v_mfma_f32_16x16x32_bf16 v[44:47], v[124:127], v[104:107], v[44:47]
    v_mfma_f32_16x16x32_bf16 v[60:63], v[124:127], v[108:111], v[60:63]
    s_waitcnt lgkmcnt(0)
    v_mfma_f32_16x16x32_bf16 v[0:3], v[80:83], v[64:67], v[0:3]
    ds_read_b128 v[96:99], v129 offset:49152
    v_mfma_f32_16x16x32_bf16 v[16:19], v[80:83], v[68:71], v[16:19]
    ds_read_b64_tr_b16 v[112:113], v130 offset:57344
    v_mfma_f32_16x16x32_bf16 v[4:7], v[84:87], v[64:67], v[4:7]
    ds_read_b64_tr_b16 v[114:115], v130 offset:58368
    v_mfma_f32_16x16x32_bf16 v[20:23], v[84:87], v[68:71], v[20:23]
    ds_read_b128 v[100:103], v129 offset:51200
    v_mfma_f32_16x16x32_bf16 v[32:35], v[80:83], v[72:75], v[32:35]
    ds_read_b64_tr_b16 v[116:117], v131 offset:57344
    v_mfma_f32_16x16x32_bf16 v[36:39], v[84:87], v[72:75], v[36:39]
    ds_read_b64_tr_b16 v[118:119], v131 offset:58368
    v_mfma_f32_16x16x32_bf16 v[8:11], v[88:91], v[64:67], v[8:11]
    ds_read_b128 v[104:107], v129 offset:53248
    v_mfma_f32_16x16x32_bf16 v[24:27], v[88:91], v[68:71], v[24:27]
    ds_read_b64_tr_b16 v[120:121], v132 offset:57344
    v_mfma_f32_16x16x32_bf16 v[40:43], v[88:91], v[72:75], v[40:43]
    ds_read_b64_tr_b16 v[122:123], v132 offset:58368
    v_mfma_f32_16x16x32_bf16 v[48:51], v[80:83], v[76:79], v[48:51]
    ds_read_b128 v[108:111], v129 offset:55296
    v_mfma_f32_16x16x32_bf16 v[52:55], v[84:87], v[76:79], v[52:55]
    ds_read_b64_tr_b16 v[124:125], v133 offset:57344
    v_mfma_f32_16x16x32_bf16 v[56:59], v[88:91], v[76:79], v[56:59]
    ds_read_b64_tr_b16 v[126:127], v133 offset:58368
    v_mfma_f32_16x16x32_bf16 v[12:15], v[92:95], v[64:67], v[12:15]
    v_mfma_f32_16x16x32_bf16 v[28:31], v[92:95], v[68:71], v[28:31]
    v_mfma_f32_16x16x32_bf16 v[44:47], v[92:95], v[72:75], v[44:47]
    v_mfma_f32_16x16x32_bf16 v[60:63], v[92:95], v[76:79], v[60:63]
    s_waitcnt lgkmcnt(0)
    s_barrier
    v_mfma_f32_16x16x32_bf16 v[0:3], v[112:115], v[96:99], v[0:3]
    ds_read_b128 v[64:67], v128 offset:0
    v_mfma_f32_16x16x32_bf16 v[16:19], v[112:115], v[100:103], v[16:19]
    ds_read_b64_tr_b16 v[80:81], v130 offset:0
    v_mfma_f32_16x16x32_bf16 v[4:7], v[116:119], v[96:99], v[4:7]
    ds_read_b64_tr_b16 v[82:83], v130 offset:1024
    v_mfma_f32_16x16x32_bf16 v[20:23], v[116:119], v[100:103], v[20:23]
    ds_read_b128 v[68:71], v128 offset:2048
    v_mfma_f32_16x16x32_bf16 v[32:35], v[112:115], v[104:107], v[32:35]
    ds_read_b64_tr_b16 v[84:85], v131 offset:0
    v_mfma_f32_16x16x32_bf16 v[36:39], v[116:119], v[104:107], v[36:39]
    ds_read_b64_tr_b16 v[86:87], v131 offset:1024
    v_mfma_f32_16x16x32_bf16 v[8:11], v[120:123], v[96:99], v[8:11]
    ds_read_b128 v[72:75], v128 offset:4096
    v_mfma_f32_16x16x32_bf16 v[24:27], v[120:123], v[100:103], v[24:27]
    ds_read_b64_tr_b16 v[88:89], v132 offset:0
    v_mfma_f32_16x16x32_bf16 v[40:43], v[120:123], v[104:107], v[40:43]
    ds_read_b64_tr_b16 v[90:91], v132 offset:1024
    v_mfma_f32_16x16x32_bf16 v[48:51], v[112:115], v[108:111], v[48:51]
    ds_read_b128 v[76:79], v128 offset:6144
    v_mfma_f32_16x16x32_bf16 v[52:55], v[116:119], v[108:111], v[52:55]
    ds_read_b64_tr_b16 v[92:93], v133 offset:0
    v_mfma_f32_16x16x32_bf16 v[56:59], v[120:123], v[108:111], v[56:59]
    ds_read_b64_tr_b16 v[94:95], v133 offset:1024
    v_mfma_f32_16x16x32_bf16 v[12:15], v[124:127], v[96:99], v[12:15]
    v_mfma_f32_16x16x32_bf16 v[28:31], v[124:127], v[100:103], v[28:31]
    v_mfma_f32_16x16x32_bf16 v[44:47], v[124:127], v[104:107], v[44:47]
    v_mfma_f32_16x16x32_bf16 v[60:63], v[124:127], v[108:111], v[60:63]
    s_waitcnt lgkmcnt(0)
    v_mfma_f32_16x16x32_bf16 v[0:3], v[80:83], v[64:67], v[0:3]
    ds_read_b128 v[96:99], v129 offset:0
    v_mfma_f32_16x16x32_bf16 v[16:19], v[80:83], v[68:71], v[16:19]
    ds_read_b64_tr_b16 v[112:113], v130 offset:8192
    v_mfma_f32_16x16x32_bf16 v[4:7], v[84:87], v[64:67], v[4:7]
    ds_read_b64_tr_b16 v[114:115], v130 offset:9216
    v_mfma_f32_16x16x32_bf16 v[20:23], v[84:87], v[68:71], v[20:23]
    ds_read_b128 v[100:103], v129 offset:2048
    v_mfma_f32_16x16x32_bf16 v[32:35], v[80:83], v[72:75], v[32:35]
    ds_read_b64_tr_b16 v[116:117], v131 offset:8192
    v_mfma_f32_16x16x32_bf16 v[36:39], v[84:87], v[72:75], v[36:39]
    ds_read_b64_tr_b16 v[118:119], v131 offset:9216
    v_mfma_f32_16x16x32_bf16 v[8:11], v[88:91], v[64:67], v[8:11]
    ds_read_b128 v[104:107], v129 offset:4096
    v_mfma_f32_16x16x32_bf16 v[24:27], v[88:91], v[68:71], v[24:27]
    ds_read_b64_tr_b16 v[120:121], v132 offset:8192
    v_mfma_f32_16x16x32_bf16 v[40:43], v[88:91], v[72:75], v[40:43]
    ds_read_b64_tr_b16 v[122:123], v132 offset:9216
    v_mfma_f32_16x16x32_bf16 v[48:51], v[80:83], v[76:79], v[48:51]
    ds_read_b128 v[108:111], v129 offset:6144
    v_mfma_f32_16x16x32_bf16 v[52:55], v[84:87], v[76:79], v[52:55]
    ds_read_b64_tr_b16 v[124:125], v133 offset:8192
    v_mfma_f32_16x16x32_bf16 v[56:59], v[88:91], v[76:79], v[56:59]
    ds_read_b64_tr_b16 v[126:127], v133 offset:9216
    v_mfma_f32_16x16x32_bf16 v[12:15], v[92:95], v[64:67], v[12:15]
    v_mfma_f32_16x16x32_bf16 v[28:31], v[92:95], v[68:71], v[28:31]
    v_mfma_f32_16x16x32_bf16 v[44:47], v[92:95], v[72:75], v[44:47]
    v_mfma_f32_16x16x32_bf16 v[60:63], v[92:95], v[76:79], v[60:63]
    s_waitcnt lgkmcnt(0)
    s_barrier
    v_mfma_f32_16x16x32_bf16 v[0:3], v[112:115], v[96:99], v[0:3]
    ds_read_b128 v[64:67], v128 offset:16384
    v_mfma_f32_16x16x32_bf16 v[16:19], v[112:115], v[100:103], v[16:19]
    ds_read_b64_tr_b16 v[80:81], v130 offset:16384
    v_mfma_f32_16x16x32_bf16 v[4:7], v[116:119], v[96:99], v[4:7]
    ds_read_b64_tr_b16 v[82:83], v130 offset:17408
    v_mfma_f32_16x16x32_bf16 v[20:23], v[116:119], v[100:103], v[20:23]
    ds_read_b128 v[68:71], v128 offset:18432
    v_mfma_f32_16x16x32_bf16 v[32:35], v[112:115], v[104:107], v[32:35]
    ds_read_b64_tr_b16 v[84:85], v131 offset:16384
    v_mfma_f32_16x16x32_bf16 v[36:39], v[116:119], v[104:107], v[36:39]
    ds_read_b64_tr_b16 v[86:87], v131 offset:17408
    v_mfma_f32_16x16x32_bf16 v[8:11], v[120:123], v[96:99], v[8:11]
    ds_read_b128 v[72:75], v128 offset:20480
    v_mfma_f32_16x16x32_bf16 v[24:27], v[120:123], v[100:103], v[24:27]
    ds_read_b64_tr_b16 v[88:89], v132 offset:16384
    v_mfma_f32_16x16x32_bf16 v[40:43], v[120:123], v[104:107], v[40:43]
    ds_read_b64_tr_b16 v[90:91], v132 offset:17408
    v_mfma_f32_16x16x32_bf16 v[48:51], v[112:115], v[108:111], v[48:51]
    ds_read_b128 v[76:79], v128 offset:22528
    v_mfma_f32_16x16x32_bf16 v[52:55], v[116:119], v[108:111], v[52:55]
    ds_read_b64_tr_b16 v[92:93], v133 offset:16384
    v_mfma_f32_16x16x32_bf16 v[56:59], v[120:123], v[108:111], v[56:59]
    ds_read_b64_tr_b16 v[94:95], v133 offset:17408
    v_mfma_f32_16x16x32_bf16 v[12:15], v[124:127], v[96:99], v[12:15]
    v_mfma_f32_16x16x32_bf16 v[28:31], v[124:127], v[100:103], v[28:31]
    v_mfma_f32_16x16x32_bf16 v[44:47], v[124:127], v[104:107], v[44:47]
    v_mfma_f32_16x16x32_bf16 v[60:63], v[124:127], v[108:111], v[60:63]
    s_waitcnt lgkmcnt(0)
    v_mfma_f32_16x16x32_bf16 v[0:3], v[80:83], v[64:67], v[0:3]
    ds_read_b128 v[96:99], v129 offset:16384
    v_mfma_f32_16x16x32_bf16 v[16:19], v[80:83], v[68:71], v[16:19]
    ds_read_b64_tr_b16 v[112:113], v130 offset:24576
    v_mfma_f32_16x16x32_bf16 v[4:7], v[84:87], v[64:67], v[4:7]
    ds_read_b64_tr_b16 v[114:115], v130 offset:25600
    v_mfma_f32_16x16x32_bf16 v[20:23], v[84:87], v[68:71], v[20:23]
    ds_read_b128 v[100:103], v129 offset:18432
    v_mfma_f32_16x16x32_bf16 v[32:35], v[80:83], v[72:75], v[32:35]
    ds_read_b64_tr_b16 v[116:117], v131 offset:24576
    v_mfma_f32_16x16x32_bf16 v[36:39], v[84:87], v[72:75], v[36:39]
    ds_read_b64_tr_b16 v[118:119], v131 offset:25600
    v_mfma_f32_16x16x32_bf16 v[8:11], v[88:91], v[64:67], v[8:11]
    ds_read_b128 v[104:107], v129 offset:20480
    v_mfma_f32_16x16x32_bf16 v[24:27], v[88:91], v[68:71], v[24:27]
    ds_read_b64_tr_b16 v[120:121], v132 offset:24576
    v_mfma_f32_16x16x32_bf16 v[40:43], v[88:91], v[72:75], v[40:43]
    ds_read_b64_tr_b16 v[122:123], v132 offset:25600
    v_mfma_f32_16x16x32_bf16 v[48:51], v[80:83], v[76:79], v[48:51]
    ds_read_b128 v[108:111], v129 offset:22528
    v_mfma_f32_16x16x32_bf16 v[52:55], v[84:87], v[76:79], v[52:55]
    ds_read_b64_tr_b16 v[124:125], v133 offset:24576
    v_mfma_f32_16x16x32_bf16 v[56:59], v[88:91], v[76:79], v[56:59]
    ds_read_b64_tr_b16 v[126:127], v133 offset:25600
    v_mfma_f32_16x16x32_bf16 v[12:15], v[92:95], v[64:67], v[12:15]
    v_mfma_f32_16x16x32_bf16 v[28:31], v[92:95], v[68:71], v[28:31]
    v_mfma_f32_16x16x32_bf16 v[44:47], v[92:95], v[72:75], v[44:47]
    v_mfma_f32_16x16x32_bf16 v[60:63], v[92:95], v[76:79], v[60:63]
    s_waitcnt lgkmcnt(0)
    s_barrier
    v_mfma_f32_16x16x32_bf16 v[0:3], v[112:115], v[96:99], v[0:3]
    ds_read_b128 v[64:67], v128 offset:32768
    v_mfma_f32_16x16x32_bf16 v[16:19], v[112:115], v[100:103], v[16:19]
    ds_read_b64_tr_b16 v[80:81], v130 offset:32768
    v_mfma_f32_16x16x32_bf16 v[4:7], v[116:119], v[96:99], v[4:7]
    ds_read_b64_tr_b16 v[82:83], v130 offset:33792
    v_mfma_f32_16x16x32_bf16 v[20:23], v[116:119], v[100:103], v[20:23]
    ds_read_b128 v[68:71], v128 offset:34816
    v_mfma_f32_16x16x32_bf16 v[32:35], v[112:115], v[104:107], v[32:35]
    ds_read_b64_tr_b16 v[84:85], v131 offset:32768
    v_mfma_f32_16x16x32_bf16 v[36:39], v[116:119], v[104:107], v[36:39]
    ds_read_b64_tr_b16 v[86:87], v131 offset:33792
    v_mfma_f32_16x16x32_bf16 v[8:11], v[120:123], v[96:99], v[8:11]
    ds_read_b128 v[72:75], v128 offset:36864
    v_mfma_f32_16x16x32_bf16 v[24:27], v[120:123], v[100:103], v[24:27]
    ds_read_b64_tr_b16 v[88:89], v132 offset:32768
    v_mfma_f32_16x16x32_bf16 v[40:43], v[120:123], v[104:107], v[40:43]
    ds_read_b64_tr_b16 v[90:91], v132 offset:33792
    v_mfma_f32_16x16x32_bf16 v[48:51], v[112:115], v[108:111], v[48:51]
    ds_read_b128 v[76:79], v128 offset:38912
    v_mfma_f32_16x16x32_bf16 v[52:55], v[116:119], v[108:111], v[52:55]
    ds_read_b64_tr_b16 v[92:93], v133 offset:32768
    v_mfma_f32_16x16x32_bf16 v[56:59], v[120:123], v[108:111], v[56:59]
    ds_read_b64_tr_b16 v[94:95], v133 offset:33792
    v_mfma_f32_16x16x32_bf16 v[12:15], v[124:127], v[96:99], v[12:15]
    v_mfma_f32_16x16x32_bf16 v[28:31], v[124:127], v[100:103], v[28:31]
    v_mfma_f32_16x16x32_bf16 v[44:47], v[124:127], v[104:107], v[44:47]
    v_mfma_f32_16x16x32_bf16 v[60:63], v[124:127], v[108:111], v[60:63]
    s_waitcnt lgkmcnt(0)
    v_mfma_f32_16x16x32_bf16 v[0:3], v[80:83], v[64:67], v[0:3]
    ds_read_b128 v[96:99], v129 offset:32768
    v_mfma_f32_16x16x32_bf16 v[16:19], v[80:83], v[68:71], v[16:19]
    ds_read_b64_tr_b16 v[112:113], v130 offset:40960
    v_mfma_f32_16x16x32_bf16 v[4:7], v[84:87], v[64:67], v[4:7]
    ds_read_b64_tr_b16 v[114:115], v130 offset:41984
    v_mfma_f32_16x16x32_bf16 v[20:23], v[84:87], v[68:71], v[20:23]
    ds_read_b128 v[100:103], v129 offset:34816
    v_mfma_f32_16x16x32_bf16 v[32:35], v[80:83], v[72:75], v[32:35]
    ds_read_b64_tr_b16 v[116:117], v131 offset:40960
    v_mfma_f32_16x16x32_bf16 v[36:39], v[84:87], v[72:75], v[36:39]
    ds_read_b64_tr_b16 v[118:119], v131 offset:41984
    v_mfma_f32_16x16x32_bf16 v[8:11], v[88:91], v[64:67], v[8:11]
    ds_read_b128 v[104:107], v129 offset:36864
    v_mfma_f32_16x16x32_bf16 v[24:27], v[88:91], v[68:71], v[24:27]
    ds_read_b64_tr_b16 v[120:121], v132 offset:40960
    v_mfma_f32_16x16x32_bf16 v[40:43], v[88:91], v[72:75], v[40:43]
    ds_read_b64_tr_b16 v[122:123], v132 offset:41984
    v_mfma_f32_16x16x32_bf16 v[48:51], v[80:83], v[76:79], v[48:51]
    ds_read_b128 v[108:111], v129 offset:38912
    v_mfma_f32_16x16x32_bf16 v[52:55], v[84:87], v[76:79], v[52:55]
    ds_read_b64_tr_b16 v[124:125], v133 offset:40960
    v_mfma_f32_16x16x32_bf16 v[56:59], v[88:91], v[76:79], v[56:59]
    ds_read_b64_tr_b16 v[126:127], v133 offset:41984
    v_mfma_f32_16x16x32_bf16 v[12:15], v[92:95], v[64:67], v[12:15]
    v_mfma_f32_16x16x32_bf16 v[28:31], v[92:95], v[68:71], v[28:31]
    v_mfma_f32_16x16x32_bf16 v[44:47], v[92:95], v[72:75], v[44:47]
    v_mfma_f32_16x16x32_bf16 v[60:63], v[92:95], v[76:79], v[60:63]
    s_waitcnt lgkmcnt(0)
    s_barrier
    v_mfma_f32_16x16x32_bf16 v[0:3], v[112:115], v[96:99], v[0:3]
    ds_read_b128 v[64:67], v128 offset:49152
    v_mfma_f32_16x16x32_bf16 v[16:19], v[112:115], v[100:103], v[16:19]
    ds_read_b64_tr_b16 v[80:81], v130 offset:49152
    v_mfma_f32_16x16x32_bf16 v[4:7], v[116:119], v[96:99], v[4:7]
    ds_read_b64_tr_b16 v[82:83], v130 offset:50176
    v_mfma_f32_16x16x32_bf16 v[20:23], v[116:119], v[100:103], v[20:23]
    ds_read_b128 v[68:71], v128 offset:51200
    v_mfma_f32_16x16x32_bf16 v[32:35], v[112:115], v[104:107], v[32:35]
    ds_read_b64_tr_b16 v[84:85], v131 offset:49152
    v_mfma_f32_16x16x32_bf16 v[36:39], v[116:119], v[104:107], v[36:39]
    ds_read_b64_tr_b16 v[86:87], v131 offset:50176
    v_mfma_f32_16x16x32_bf16 v[8:11], v[120:123], v[96:99], v[8:11]
    ds_read_b128 v[72:75], v128 offset:53248
    v_mfma_f32_16x16x32_bf16 v[24:27], v[120:123], v[100:103], v[24:27]
    ds_read_b64_tr_b16 v[88:89], v132 offset:49152
    v_mfma_f32_16x16x32_bf16 v[40:43], v[120:123], v[104:107], v[40:43]
    ds_read_b64_tr_b16 v[90:91], v132 offset:50176
    v_mfma_f32_16x16x32_bf16 v[48:51], v[112:115], v[108:111], v[48:51]
    ds_read_b128 v[76:79], v128 offset:55296
    v_mfma_f32_16x16x32_bf16 v[52:55], v[116:119], v[108:111], v[52:55]
    ds_read_b64_tr_b16 v[92:93], v133 offset:49152
    v_mfma_f32_16x16x32_bf16 v[56:59], v[120:123], v[108:111], v[56:59]
    ds_read_b64_tr_b16 v[94:95], v133 offset:50176
    v_mfma_f32_16x16x32_bf16 v[12:15], v[124:127], v[96:99], v[12:15]
    v_mfma_f32_16x16x32_bf16 v[28:31], v[124:127], v[100:103], v[28:31]
    v_mfma_f32_16x16x32_bf16 v[44:47], v[124:127], v[104:107], v[44:47]
    v_mfma_f32_16x16x32_bf16 v[60:63], v[124:127], v[108:111], v[60:63]
    s_waitcnt lgkmcnt(0)
    v_mfma_f32_16x16x32_bf16 v[0:3], v[80:83], v[64:67], v[0:3]
    ds_read_b128 v[96:99], v129 offset:49152
    v_mfma_f32_16x16x32_bf16 v[16:19], v[80:83], v[68:71], v[16:19]
    ds_read_b64_tr_b16 v[112:113], v130 offset:57344
    v_mfma_f32_16x16x32_bf16 v[4:7], v[84:87], v[64:67], v[4:7]
    ds_read_b64_tr_b16 v[114:115], v130 offset:58368
    v_mfma_f32_16x16x32_bf16 v[20:23], v[84:87], v[68:71], v[20:23]
    ds_read_b128 v[100:103], v129 offset:51200
    v_mfma_f32_16x16x32_bf16 v[32:35], v[80:83], v[72:75], v[32:35]
    ds_read_b64_tr_b16 v[116:117], v131 offset:57344
    v_mfma_f32_16x16x32_bf16 v[36:39], v[84:87], v[72:75], v[36:39]
    ds_read_b64_tr_b16 v[118:119], v131 offset:58368
    v_mfma_f32_16x16x32_bf16 v[8:11], v[88:91], v[64:67], v[8:11]
    ds_read_b128 v[104:107], v129 offset:53248
    v_mfma_f32_16x16x32_bf16 v[24:27], v[88:91], v[68:71], v[24:27]
    ds_read_b64_tr_b16 v[120:121], v132 offset:57344
    v_mfma_f32_16x16x32_bf16 v[40:43], v[88:91], v[72:75], v[40:43]
    ds_read_b64_tr_b16 v[122:123], v132 offset:58368
    v_mfma_f32_16x16x32_bf16 v[48:51], v[80:83], v[76:79], v[48:51]
    ds_read_b128 v[108:111], v129 offset:55296
    v_mfma_f32_16x16x32_bf16 v[52:55], v[84:87], v[76:79], v[52:55]
    ds_read_b64_tr_b16 v[124:125], v133 offset:57344
    v_mfma_f32_16x16x32_bf16 v[56:59], v[88:91], v[76:79], v[56:59]
    ds_read_b64_tr_b16 v[126:127], v133 offset:58368
    v_mfma_f32_16x16x32_bf16 v[12:15], v[92:95], v[64:67], v[12:15]
    v_mfma_f32_16x16x32_bf16 v[28:31], v[92:95], v[68:71], v[28:31]
    v_mfma_f32_16x16x32_bf16 v[44:47], v[92:95], v[72:75], v[44:47]
    v_mfma_f32_16x16x32_bf16 v[60:63], v[92:95], v[76:79], v[60:63]
    s_waitcnt lgkmcnt(0)
    s_barrier
    v_mfma_f32_16x16x32_bf16 v[0:3], v[112:115], v[96:99], v[0:3]
    ds_read_b128 v[64:67], v128 offset:0
    v_mfma_f32_16x16x32_bf16 v[16:19], v[112:115], v[100:103], v[16:19]
    ds_read_b64_tr_b16 v[80:81], v130 offset:0
    v_mfma_f32_16x16x32_bf16 v[4:7], v[116:119], v[96:99], v[4:7]
    ds_read_b64_tr_b16 v[82:83], v130 offset:1024
    v_mfma_f32_16x16x32_bf16 v[20:23], v[116:119], v[100:103], v[20:23]
    ds_read_b128 v[68:71], v128 offset:2048
    v_mfma_f32_16x16x32_bf16 v[32:35], v[112:115], v[104:107], v[32:35]
    ds_read_b64_tr_b16 v[84:85], v131 offset:0
    v_mfma_f32_16x16x32_bf16 v[36:39], v[116:119], v[104:107], v[36:39]
    ds_read_b64_tr_b16 v[86:87], v131 offset:1024
    v_mfma_f32_16x16x32_bf16 v[8:11], v[120:123], v[96:99], v[8:11]
    ds_read_b128 v[72:75], v128 offset:4096
    v_mfma_f32_16x16x32_bf16 v[24:27], v[120:123], v[100:103], v[24:27]
    ds_read_b64_tr_b16 v[88:89], v132 offset:0
    v_mfma_f32_16x16x32_bf16 v[40:43], v[120:123], v[104:107], v[40:43]
    ds_read_b64_tr_b16 v[90:91], v132 offset:1024
    v_mfma_f32_16x16x32_bf16 v[48:51], v[112:115], v[108:111], v[48:51]
    ds_read_b128 v[76:79], v128 offset:6144
    v_mfma_f32_16x16x32_bf16 v[52:55], v[116:119], v[108:111], v[52:55]
    ds_read_b64_tr_b16 v[92:93], v133 offset:0
    v_mfma_f32_16x16x32_bf16 v[56:59], v[120:123], v[108:111], v[56:59]
    ds_read_b64_tr_b16 v[94:95], v133 offset:1024
    v_mfma_f32_16x16x32_bf16 v[12:15], v[124:127], v[96:99], v[12:15]
    v_mfma_f32_16x16x32_bf16 v[28:31], v[124:127], v[100:103], v[28:31]
    v_mfma_f32_16x16x32_bf16 v[44:47], v[124:127], v[104:107], v[44:47]
    v_mfma_f32_16x16x32_bf16 v[60:63], v[124:127], v[108:111], v[60:63]
    s_waitcnt lgkmcnt(0)
    v_mfma_f32_16x16x32_bf16 v[0:3], v[80:83], v[64:67], v[0:3]
    ds_read_b128 v[96:99], v129 offset:0
    v_mfma_f32_16x16x32_bf16 v[16:19], v[80:83], v[68:71], v[16:19]
    ds_read_b64_tr_b16 v[112:113], v130 offset:8192
    v_mfma_f32_16x16x32_bf16 v[4:7], v[84:87], v[64:67], v[4:7]
    ds_read_b64_tr_b16 v[114:115], v130 offset:9216
    v_mfma_f32_16x16x32_bf16 v[20:23], v[84:87], v[68:71], v[20:23]
    ds_read_b128 v[100:103], v129 offset:2048
    v_mfma_f32_16x16x32_bf16 v[32:35], v[80:83], v[72:75], v[32:35]
    ds_read_b64_tr_b16 v[116:117], v131 offset:8192
    v_mfma_f32_16x16x32_bf16 v[36:39], v[84:87], v[72:75], v[36:39]
    ds_read_b64_tr_b16 v[118:119], v131 offset:9216
    v_mfma_f32_16x16x32_bf16 v[8:11], v[88:91], v[64:67], v[8:11]
    ds_read_b128 v[104:107], v129 offset:4096
    v_mfma_f32_16x16x32_bf16 v[24:27], v[88:91], v[68:71], v[24:27]
    ds_read_b64_tr_b16 v[120:121], v132 offset:8192
    v_mfma_f32_16x16x32_bf16 v[40:43], v[88:91], v[72:75], v[40:43]
    ds_read_b64_tr_b16 v[122:123], v132 offset:9216
    v_mfma_f32_16x16x32_bf16 v[48:51], v[80:83], v[76:79], v[48:51]
    ds_read_b128 v[108:111], v129 offset:6144
    v_mfma_f32_16x16x32_bf16 v[52:55], v[84:87], v[76:79], v[52:55]
    ds_read_b64_tr_b16 v[124:125], v133 offset:8192
    v_mfma_f32_16x16x32_bf16 v[56:59], v[88:91], v[76:79], v[56:59]
    ds_read_b64_tr_b16 v[126:127], v133 offset:9216
    v_mfma_f32_16x16x32_bf16 v[12:15], v[92:95], v[64:67], v[12:15]
    v_mfma_f32_16x16x32_bf16 v[28:31], v[92:95], v[68:71], v[28:31]
    v_mfma_f32_16x16x32_bf16 v[44:47], v[92:95], v[72:75], v[44:47]
    v_mfma_f32_16x16x32_bf16 v[60:63], v[92:95], v[76:79], v[60:63]
    s_waitcnt lgkmcnt(0)
    s_barrier
    v_mfma_f32_16x16x32_bf16 v[0:3], v[112:115], v[96:99], v[0:3]
    ds_read_b128 v[64:67], v128 offset:16384
    v_mfma_f32_16x16x32_bf16 v[16:19], v[112:115], v[100:103], v[16:19]
    ds_read_b64_tr_b16 v[80:81], v130 offset:16384
    v_mfma_f32_16x16x32_bf16 v[4:7], v[116:119], v[96:99], v[4:7]
    ds_read_b64_tr_b16 v[82:83], v130 offset:17408
    v_mfma_f32_16x16x32_bf16 v[20:23], v[116:119], v[100:103], v[20:23]
    ds_read_b128 v[68:71], v128 offset:18432
    v_mfma_f32_16x16x32_bf16 v[32:35], v[112:115], v[104:107], v[32:35]
    ds_read_b64_tr_b16 v[84:85], v131 offset:16384
    v_mfma_f32_16x16x32_bf16 v[36:39], v[116:119], v[104:107], v[36:39]
    ds_read_b64_tr_b16 v[86:87], v131 offset:17408
    v_mfma_f32_16x16x32_bf16 v[8:11], v[120:123], v[96:99], v[8:11]
    ds_read_b128 v[72:75], v128 offset:20480
    v_mfma_f32_16x16x32_bf16 v[24:27], v[120:123], v[100:103], v[24:27]
    ds_read_b64_tr_b16 v[88:89], v132 offset:16384
    v_mfma_f32_16x16x32_bf16 v[40:43], v[120:123], v[104:107], v[40:43]
    ds_read_b64_tr_b16 v[90:91], v132 offset:17408
    v_mfma_f32_16x16x32_bf16 v[48:51], v[112:115], v[108:111], v[48:51]
    ds_read_b128 v[76:79], v128 offset:22528
    v_mfma_f32_16x16x32_bf16 v[52:55], v[116:119], v[108:111], v[52:55]
    ds_read_b64_tr_b16 v[92:93], v133 offset:16384
    v_mfma_f32_16x16x32_bf16 v[56:59], v[120:123], v[108:111], v[56:59]
    ds_read_b64_tr_b16 v[94:95], v133 offset:17408
    v_mfma_f32_16x16x32_bf16 v[12:15], v[124:127], v[96:99], v[12:15]
    v_mfma_f32_16x16x32_bf16 v[28:31], v[124:127], v[100:103], v[28:31]
    v_mfma_f32_16x16x32_bf16 v[44:47], v[124:127], v[104:107], v[44:47]
    v_mfma_f32_16x16x32_bf16 v[60:63], v[124:127], v[108:111], v[60:63]
    s_waitcnt lgkmcnt(0)
    v_mfma_f32_16x16x32_bf16 v[0:3], v[80:83], v[64:67], v[0:3]
    ds_read_b128 v[96:99], v129 offset:16384
    v_mfma_f32_16x16x32_bf16 v[16:19], v[80:83], v[68:71], v[16:19]
    ds_read_b64_tr_b16 v[112:113], v130 offset:24576
    v_mfma_f32_16x16x32_bf16 v[4:7], v[84:87], v[64:67], v[4:7]
    ds_read_b64_tr_b16 v[114:115], v130 offset:25600
    v_mfma_f32_16x16x32_bf16 v[20:23], v[84:87], v[68:71], v[20:23]
    ds_read_b128 v[100:103], v129 offset:18432
    v_mfma_f32_16x16x32_bf16 v[32:35], v[80:83], v[72:75], v[32:35]
    ds_read_b64_tr_b16 v[116:117], v131 offset:24576
    v_mfma_f32_16x16x32_bf16 v[36:39], v[84:87], v[72:75], v[36:39]
    ds_read_b64_tr_b16 v[118:119], v131 offset:25600
    v_mfma_f32_16x16x32_bf16 v[8:11], v[88:91], v[64:67], v[8:11]
    ds_read_b128 v[104:107], v129 offset:20480
    v_mfma_f32_16x16x32_bf16 v[24:27], v[88:91], v[68:71], v[24:27]
    ds_read_b64_tr_b16 v[120:121], v132 offset:24576
    v_mfma_f32_16x16x32_bf16 v[40:43], v[88:91], v[72:75], v[40:43]
    ds_read_b64_tr_b16 v[122:123], v132 offset:25600
    v_mfma_f32_16x16x32_bf16 v[48:51], v[80:83], v[76:79], v[48:51]
    ds_read_b128 v[108:111], v129 offset:22528
    v_mfma_f32_16x16x32_bf16 v[52:55], v[84:87], v[76:79], v[52:55]
    ds_read_b64_tr_b16 v[124:125], v133 offset:24576
    v_mfma_f32_16x16x32_bf16 v[56:59], v[88:91], v[76:79], v[56:59]
    ds_read_b64_tr_b16 v[126:127], v133 offset:25600
    v_mfma_f32_16x16x32_bf16 v[12:15], v[92:95], v[64:67], v[12:15]
    v_mfma_f32_16x16x32_bf16 v[28:31], v[92:95], v[68:71], v[28:31]
    v_mfma_f32_16x16x32_bf16 v[44:47], v[92:95], v[72:75], v[44:47]
    v_mfma_f32_16x16x32_bf16 v[60:63], v[92:95], v[76:79], v[60:63]
    s_waitcnt lgkmcnt(0)
    s_barrier
    v_mfma_f32_16x16x32_bf16 v[0:3], v[112:115], v[96:99], v[0:3]
    ds_read_b128 v[64:67], v128 offset:32768
    v_mfma_f32_16x16x32_bf16 v[16:19], v[112:115], v[100:103], v[16:19]
    ds_read_b64_tr_b16 v[80:81], v130 offset:32768
    v_mfma_f32_16x16x32_bf16 v[4:7], v[116:119], v[96:99], v[4:7]
    ds_read_b64_tr_b16 v[82:83], v130 offset:33792
    v_mfma_f32_16x16x32_bf16 v[20:23], v[116:119], v[100:103], v[20:23]
    ds_read_b128 v[68:71], v128 offset:34816
    v_mfma_f32_16x16x32_bf16 v[32:35], v[112:115], v[104:107], v[32:35]
    ds_read_b64_tr_b16 v[84:85], v131 offset:32768
    v_mfma_f32_16x16x32_bf16 v[36:39], v[116:119], v[104:107], v[36:39]
    ds_read_b64_tr_b16 v[86:87], v131 offset:33792
    v_mfma_f32_16x16x32_bf16 v[8:11], v[120:123], v[96:99], v[8:11]
    ds_read_b128 v[72:75], v128 offset:36864
    v_mfma_f32_16x16x32_bf16 v[24:27], v[120:123], v[100:103], v[24:27]
    ds_read_b64_tr_b16 v[88:89], v132 offset:32768
    v_mfma_f32_16x16x32_bf16 v[40:43], v[120:123], v[104:107], v[40:43]
    ds_read_b64_tr_b16 v[90:91], v132 offset:33792
    v_mfma_f32_16x16x32_bf16 v[48:51], v[112:115], v[108:111], v[48:51]
    ds_read_b128 v[76:79], v128 offset:38912
    v_mfma_f32_16x16x32_bf16 v[52:55], v[116:119], v[108:111], v[52:55]
    ds_read_b64_tr_b16 v[92:93], v133 offset:32768
    v_mfma_f32_16x16x32_bf16 v[56:59], v[120:123], v[108:111], v[56:59]
    ds_read_b64_tr_b16 v[94:95], v133 offset:33792
    v_mfma_f32_16x16x32_bf16 v[12:15], v[124:127], v[96:99], v[12:15]
    v_mfma_f32_16x16x32_bf16 v[28:31], v[124:127], v[100:103], v[28:31]
    v_mfma_f32_16x16x32_bf16 v[44:47], v[124:127], v[104:107], v[44:47]
    v_mfma_f32_16x16x32_bf16 v[60:63], v[124:127], v[108:111], v[60:63]
    s_waitcnt lgkmcnt(0)
    v_mfma_f32_16x16x32_bf16 v[0:3], v[80:83], v[64:67], v[0:3]
    ds_read_b128 v[96:99], v129 offset:32768
    v_mfma_f32_16x16x32_bf16 v[16:19], v[80:83], v[68:71], v[16:19]
    ds_read_b64_tr_b16 v[112:113], v130 offset:40960
    v_mfma_f32_16x16x32_bf16 v[4:7], v[84:87], v[64:67], v[4:7]
    ds_read_b64_tr_b16 v[114:115], v130 offset:41984
    v_mfma_f32_16x16x32_bf16 v[20:23], v[84:87], v[68:71], v[20:23]
    ds_read_b128 v[100:103], v129 offset:34816
    v_mfma_f32_16x16x32_bf16 v[32:35], v[80:83], v[72:75], v[32:35]
    ds_read_b64_tr_b16 v[116:117], v131 offset:40960
    v_mfma_f32_16x16x32_bf16 v[36:39], v[84:87], v[72:75], v[36:39]
    ds_read_b64_tr_b16 v[118:119], v131 offset:41984
    v_mfma_f32_16x16x32_bf16 v[8:11], v[88:91], v[64:67], v[8:11]
    ds_read_b128 v[104:107], v129 offset:36864
    v_mfma_f32_16x16x32_bf16 v[24:27], v[88:91], v[68:71], v[24:27]
    ds_read_b64_tr_b16 v[120:121], v132 offset:40960
    v_mfma_f32_16x16x32_bf16 v[40:43], v[88:91], v[72:75], v[40:43]
    ds_read_b64_tr_b16 v[122:123], v132 offset:41984
    v_mfma_f32_16x16x32_bf16 v[48:51], v[80:83], v[76:79], v[48:51]
    ds_read_b128 v[108:111], v129 offset:38912
    v_mfma_f32_16x16x32_bf16 v[52:55], v[84:87], v[76:79], v[52:55]
    ds_read_b64_tr_b16 v[124:125], v133 offset:40960
    v_mfma_f32_16x16x32_bf16 v[56:59], v[88:91], v[76:79], v[56:59]
    ds_read_b64_tr_b16 v[126:127], v133 offset:41984
    v_mfma_f32_16x16x32_bf16 v[12:15], v[92:95], v[64:67], v[12:15]
    v_mfma_f32_16x16x32_bf16 v[28:31], v[92:95], v[68:71], v[28:31]
    v_mfma_f32_16x16x32_bf16 v[44:47], v[92:95], v[72:75], v[44:47]
    v_mfma_f32_16x16x32_bf16 v[60:63], v[92:95], v[76:79], v[60:63]
    s_waitcnt lgkmcnt(0)
    s_barrier
    v_mfma_f32_16x16x32_bf16 v[0:3], v[112:115], v[96:99], v[0:3]
    ds_read_b128 v[64:67], v128 offset:49152
    v_mfma_f32_16x16x32_bf16 v[16:19], v[112:115], v[100:103], v[16:19]
    ds_read_b64_tr_b16 v[80:81], v130 offset:49152
    v_mfma_f32_16x16x32_bf16 v[4:7], v[116:119], v[96:99], v[4:7]
    ds_read_b64_tr_b16 v[82:83], v130 offset:50176
    v_mfma_f32_16x16x32_bf16 v[20:23], v[116:119], v[100:103], v[20:23]
    ds_read_b128 v[68:71], v128 offset:51200
    v_mfma_f32_16x16x32_bf16 v[32:35], v[112:115], v[104:107], v[32:35]
    ds_read_b64_tr_b16 v[84:85], v131 offset:49152
    v_mfma_f32_16x16x32_bf16 v[36:39], v[116:119], v[104:107], v[36:39]
    ds_read_b64_tr_b16 v[86:87], v131 offset:50176
    v_mfma_f32_16x16x32_bf16 v[8:11], v[120:123], v[96:99], v[8:11]
    ds_read_b128 v[72:75], v128 offset:53248
    v_mfma_f32_16x16x32_bf16 v[24:27], v[120:123], v[100:103], v[24:27]
    ds_read_b64_tr_b16 v[88:89], v132 offset:49152
    v_mfma_f32_16x16x32_bf16 v[40:43], v[120:123], v[104:107], v[40:43]
    ds_read_b64_tr_b16 v[90:91], v132 offset:50176
    v_mfma_f32_16x16x32_bf16 v[48:51], v[112:115], v[108:111], v[48:51]
    ds_read_b128 v[76:79], v128 offset:55296
    v_mfma_f32_16x16x32_bf16 v[52:55], v[116:119], v[108:111], v[52:55]
    ds_read_b64_tr_b16 v[92:93], v133 offset:49152
    v_mfma_f32_16x16x32_bf16 v[56:59], v[120:123], v[108:111], v[56:59]
    ds_read_b64_tr_b16 v[94:95], v133 offset:50176
    v_mfma_f32_16x16x32_bf16 v[12:15], v[124:127], v[96:99], v[12:15]
    v_mfma_f32_16x16x32_bf16 v[28:31], v[124:127], v[100:103], v[28:31]
    v_mfma_f32_16x16x32_bf16 v[44:47], v[124:127], v[104:107], v[44:47]
    v_mfma_f32_16x16x32_bf16 v[60:63], v[124:127], v[108:111], v[60:63]
    s_waitcnt lgkmcnt(0)
    v_mfma_f32_16x16x32_bf16 v[0:3], v[80:83], v[64:67], v[0:3]
    ds_read_b128 v[96:99], v129 offset:49152
    v_mfma_f32_16x16x32_bf16 v[16:19], v[80:83], v[68:71], v[16:19]
    ds_read_b64_tr_b16 v[112:113], v130 offset:57344
    v_mfma_f32_16x16x32_bf16 v[4:7], v[84:87], v[64:67], v[4:7]
    ds_read_b64_tr_b16 v[114:115], v130 offset:58368
    v_mfma_f32_16x16x32_bf16 v[20:23], v[84:87], v[68:71], v[20:23]
    ds_read_b128 v[100:103], v129 offset:51200
    v_mfma_f32_16x16x32_bf16 v[32:35], v[80:83], v[72:75], v[32:35]
    ds_read_b64_tr_b16 v[116:117], v131 offset:57344
    v_mfma_f32_16x16x32_bf16 v[36:39], v[84:87], v[72:75], v[36:39]
    ds_read_b64_tr_b16 v[118:119], v131 offset:58368
    v_mfma_f32_16x16x32_bf16 v[8:11], v[88:91], v[64:67], v[8:11]
    ds_read_b128 v[104:107], v129 offset:53248
    v_mfma_f32_16x16x32_bf16 v[24:27], v[88:91], v[68:71], v[24:27]
    ds_read_b64_tr_b16 v[120:121], v132 offset:57344
    v_mfma_f32_16x16x32_bf16 v[40:43], v[88:91], v[72:75], v[40:43]
    ds_read_b64_tr_b16 v[122:123], v132 offset:58368
    v_mfma_f32_16x16x32_bf16 v[48:51], v[80:83], v[76:79], v[48:51]
    ds_read_b128 v[108:111], v129 offset:55296
    v_mfma_f32_16x16x32_bf16 v[52:55], v[84:87], v[76:79], v[52:55]
    ds_read_b64_tr_b16 v[124:125], v133 offset:57344
    v_mfma_f32_16x16x32_bf16 v[56:59], v[88:91], v[76:79], v[56:59]
    ds_read_b64_tr_b16 v[126:127], v133 offset:58368
    v_mfma_f32_16x16x32_bf16 v[12:15], v[92:95], v[64:67], v[12:15]
    v_mfma_f32_16x16x32_bf16 v[28:31], v[92:95], v[68:71], v[28:31]
    v_mfma_f32_16x16x32_bf16 v[44:47], v[92:95], v[72:75], v[44:47]
    v_mfma_f32_16x16x32_bf16 v[60:63], v[92:95], v[76:79], v[60:63]
    s_waitcnt lgkmcnt(0)
    s_barrier
    v_mfma_f32_16x16x32_bf16 v[0:3], v[112:115], v[96:99], v[0:3]
    ds_read_b128 v[64:67], v128 offset:0
    v_mfma_f32_16x16x32_bf16 v[16:19], v[112:115], v[100:103], v[16:19]
    ds_read_b64_tr_b16 v[80:81], v130 offset:0
    v_mfma_f32_16x16x32_bf16 v[4:7], v[116:119], v[96:99], v[4:7]
    ds_read_b64_tr_b16 v[82:83], v130 offset:1024
    v_mfma_f32_16x16x32_bf16 v[20:23], v[116:119], v[100:103], v[20:23]
    ds_read_b128 v[68:71], v128 offset:2048
    v_mfma_f32_16x16x32_bf16 v[32:35], v[112:115], v[104:107], v[32:35]
    ds_read_b64_tr_b16 v[84:85], v131 offset:0
    v_mfma_f32_16x16x32_bf16 v[36:39], v[116:119], v[104:107], v[36:39]
    ds_read_b64_tr_b16 v[86:87], v131 offset:1024
    v_mfma_f32_16x16x32_bf16 v[8:11], v[120:123], v[96:99], v[8:11]
    ds_read_b128 v[72:75], v128 offset:4096
    v_mfma_f32_16x16x32_bf16 v[24:27], v[120:123], v[100:103], v[24:27]
    ds_read_b64_tr_b16 v[88:89], v132 offset:0
    v_mfma_f32_16x16x32_bf16 v[40:43], v[120:123], v[104:107], v[40:43]
    ds_read_b64_tr_b16 v[90:91], v132 offset:1024
    v_mfma_f32_16x16x32_bf16 v[48:51], v[112:115], v[108:111], v[48:51]
    ds_read_b128 v[76:79], v128 offset:6144
    v_mfma_f32_16x16x32_bf16 v[52:55], v[116:119], v[108:111], v[52:55]
    ds_read_b64_tr_b16 v[92:93], v133 offset:0
    v_mfma_f32_16x16x32_bf16 v[56:59], v[120:123], v[108:111], v[56:59]
    ds_read_b64_tr_b16 v[94:95], v133 offset:1024
    v_mfma_f32_16x16x32_bf16 v[12:15], v[124:127], v[96:99], v[12:15]
    v_mfma_f32_16x16x32_bf16 v[28:31], v[124:127], v[100:103], v[28:31]
    v_mfma_f32_16x16x32_bf16 v[44:47], v[124:127], v[104:107], v[44:47]
    v_mfma_f32_16x16x32_bf16 v[60:63], v[124:127], v[108:111], v[60:63]
    s_waitcnt lgkmcnt(0)
    v_mfma_f32_16x16x32_bf16 v[0:3], v[80:83], v[64:67], v[0:3]
    ds_read_b128 v[96:99], v129 offset:0
    v_mfma_f32_16x16x32_bf16 v[16:19], v[80:83], v[68:71], v[16:19]
    ds_read_b64_tr_b16 v[112:113], v130 offset:8192
    v_mfma_f32_16x16x32_bf16 v[4:7], v[84:87], v[64:67], v[4:7]
    ds_read_b64_tr_b16 v[114:115], v130 offset:9216
    v_mfma_f32_16x16x32_bf16 v[20:23], v[84:87], v[68:71], v[20:23]
    ds_read_b128 v[100:103], v129 offset:2048
    v_mfma_f32_16x16x32_bf16 v[32:35], v[80:83], v[72:75], v[32:35]
    ds_read_b64_tr_b16 v[116:117], v131 offset:8192
    v_mfma_f32_16x16x32_bf16 v[36:39], v[84:87], v[72:75], v[36:39]
    ds_read_b64_tr_b16 v[118:119], v131 offset:9216
    v_mfma_f32_16x16x32_bf16 v[8:11], v[88:91], v[64:67], v[8:11]
    ds_read_b128 v[104:107], v129 offset:4096
    v_mfma_f32_16x16x32_bf16 v[24:27], v[88:91], v[68:71], v[24:27]
    ds_read_b64_tr_b16 v[120:121], v132 offset:8192
    v_mfma_f32_16x16x32_bf16 v[40:43], v[88:91], v[72:75], v[40:43]
    ds_read_b64_tr_b16 v[122:123], v132 offset:9216
    v_mfma_f32_16x16x32_bf16 v[48:51], v[80:83], v[76:79], v[48:51]
    ds_read_b128 v[108:111], v129 offset:6144
    v_mfma_f32_16x16x32_bf16 v[52:55], v[84:87], v[76:79], v[52:55]
    ds_read_b64_tr_b16 v[124:125], v133 offset:8192
    v_mfma_f32_16x16x32_bf16 v[56:59], v[88:91], v[76:79], v[56:59]
    ds_read_b64_tr_b16 v[126:127], v133 offset:9216
    v_mfma_f32_16x16x32_bf16 v[12:15], v[92:95], v[64:67], v[12:15]
    v_mfma_f32_16x16x32_bf16 v[28:31], v[92:95], v[68:71], v[28:31]
    v_mfma_f32_16x16x32_bf16 v[44:47], v[92:95], v[72:75], v[44:47]
    v_mfma_f32_16x16x32_bf16 v[60:63], v[92:95], v[76:79], v[60:63]
    s_waitcnt lgkmcnt(0)
    s_barrier
    v_mfma_f32_16x16x32_bf16 v[0:3], v[112:115], v[96:99], v[0:3]
    ds_read_b128 v[64:67], v128 offset:16384
    v_mfma_f32_16x16x32_bf16 v[16:19], v[112:115], v[100:103], v[16:19]
    ds_read_b64_tr_b16 v[80:81], v130 offset:16384
    v_mfma_f32_16x16x32_bf16 v[4:7], v[116:119], v[96:99], v[4:7]
    ds_read_b64_tr_b16 v[82:83], v130 offset:17408
    v_mfma_f32_16x16x32_bf16 v[20:23], v[116:119], v[100:103], v[20:23]
    ds_read_b128 v[68:71], v128 offset:18432
    v_mfma_f32_16x16x32_bf16 v[32:35], v[112:115], v[104:107], v[32:35]
    ds_read_b64_tr_b16 v[84:85], v131 offset:16384
    v_mfma_f32_16x16x32_bf16 v[36:39], v[116:119], v[104:107], v[36:39]
    ds_read_b64_tr_b16 v[86:87], v131 offset:17408
    v_mfma_f32_16x16x32_bf16 v[8:11], v[120:123], v[96:99], v[8:11]
    ds_read_b128 v[72:75], v128 offset:20480
    v_mfma_f32_16x16x32_bf16 v[24:27], v[120:123], v[100:103], v[24:27]
    ds_read_b64_tr_b16 v[88:89], v132 offset:16384
    v_mfma_f32_16x16x32_bf16 v[40:43], v[120:123], v[104:107], v[40:43]
    ds_read_b64_tr_b16 v[90:91], v132 offset:17408
    v_mfma_f32_16x16x32_bf16 v[48:51], v[112:115], v[108:111], v[48:51]
    ds_read_b128 v[76:79], v128 offset:22528
    v_mfma_f32_16x16x32_bf16 v[52:55], v[116:119], v[108:111], v[52:55]
    ds_read_b64_tr_b16 v[92:93], v133 offset:16384
    v_mfma_f32_16x16x32_bf16 v[56:59], v[120:123], v[108:111], v[56:59]
    ds_read_b64_tr_b16 v[94:95], v133 offset:17408
    v_mfma_f32_16x16x32_bf16 v[12:15], v[124:127], v[96:99], v[12:15]
    v_mfma_f32_16x16x32_bf16 v[28:31], v[124:127], v[100:103], v[28:31]
    v_mfma_f32_16x16x32_bf16 v[44:47], v[124:127], v[104:107], v[44:47]
    v_mfma_f32_16x16x32_bf16 v[60:63], v[124:127], v[108:111], v[60:63]
    s_waitcnt lgkmcnt(0)
    v_mfma_f32_16x16x32_bf16 v[0:3], v[80:83], v[64:67], v[0:3]
    ds_read_b128 v[96:99], v129 offset:16384
    v_mfma_f32_16x16x32_bf16 v[16:19], v[80:83], v[68:71], v[16:19]
    ds_read_b64_tr_b16 v[112:113], v130 offset:24576
    v_mfma_f32_16x16x32_bf16 v[4:7], v[84:87], v[64:67], v[4:7]
    ds_read_b64_tr_b16 v[114:115], v130 offset:25600
    v_mfma_f32_16x16x32_bf16 v[20:23], v[84:87], v[68:71], v[20:23]
    ds_read_b128 v[100:103], v129 offset:18432
    v_mfma_f32_16x16x32_bf16 v[32:35], v[80:83], v[72:75], v[32:35]
    ds_read_b64_tr_b16 v[116:117], v131 offset:24576
    v_mfma_f32_16x16x32_bf16 v[36:39], v[84:87], v[72:75], v[36:39]
    ds_read_b64_tr_b16 v[118:119], v131 offset:25600
    v_mfma_f32_16x16x32_bf16 v[8:11], v[88:91], v[64:67], v[8:11]
    ds_read_b128 v[104:107], v129 offset:20480
    v_mfma_f32_16x16x32_bf16 v[24:27], v[88:91], v[68:71], v[24:27]
    ds_read_b64_tr_b16 v[120:121], v132 offset:24576
    v_mfma_f32_16x16x32_bf16 v[40:43], v[88:91], v[72:75], v[40:43]
    ds_read_b64_tr_b16 v[122:123], v132 offset:25600
    v_mfma_f32_16x16x32_bf16 v[48:51], v[80:83], v[76:79], v[48:51]
    ds_read_b128 v[108:111], v129 offset:22528
    v_mfma_f32_16x16x32_bf16 v[52:55], v[84:87], v[76:79], v[52:55]
    ds_read_b64_tr_b16 v[124:125], v133 offset:24576
    v_mfma_f32_16x16x32_bf16 v[56:59], v[88:91], v[76:79], v[56:59]
    ds_read_b64_tr_b16 v[126:127], v133 offset:25600
    v_mfma_f32_16x16x32_bf16 v[12:15], v[92:95], v[64:67], v[12:15]
    v_mfma_f32_16x16x32_bf16 v[28:31], v[92:95], v[68:71], v[28:31]
    v_mfma_f32_16x16x32_bf16 v[44:47], v[92:95], v[72:75], v[44:47]
    v_mfma_f32_16x16x32_bf16 v[60:63], v[92:95], v[76:79], v[60:63]
    s_waitcnt lgkmcnt(0)
    s_barrier
    v_mfma_f32_16x16x32_bf16 v[0:3], v[112:115], v[96:99], v[0:3]
    ds_read_b128 v[64:67], v128 offset:32768
    v_mfma_f32_16x16x32_bf16 v[16:19], v[112:115], v[100:103], v[16:19]
    ds_read_b64_tr_b16 v[80:81], v130 offset:32768
    v_mfma_f32_16x16x32_bf16 v[4:7], v[116:119], v[96:99], v[4:7]
    ds_read_b64_tr_b16 v[82:83], v130 offset:33792
    v_mfma_f32_16x16x32_bf16 v[20:23], v[116:119], v[100:103], v[20:23]
    ds_read_b128 v[68:71], v128 offset:34816
    v_mfma_f32_16x16x32_bf16 v[32:35], v[112:115], v[104:107], v[32:35]
    ds_read_b64_tr_b16 v[84:85], v131 offset:32768
    v_mfma_f32_16x16x32_bf16 v[36:39], v[116:119], v[104:107], v[36:39]
    ds_read_b64_tr_b16 v[86:87], v131 offset:33792
    v_mfma_f32_16x16x32_bf16 v[8:11], v[120:123], v[96:99], v[8:11]
    ds_read_b128 v[72:75], v128 offset:36864
    v_mfma_f32_16x16x32_bf16 v[24:27], v[120:123], v[100:103], v[24:27]
    ds_read_b64_tr_b16 v[88:89], v132 offset:32768
    v_mfma_f32_16x16x32_bf16 v[40:43], v[120:123], v[104:107], v[40:43]
    ds_read_b64_tr_b16 v[90:91], v132 offset:33792
    v_mfma_f32_16x16x32_bf16 v[48:51], v[112:115], v[108:111], v[48:51]
    ds_read_b128 v[76:79], v128 offset:38912
    v_mfma_f32_16x16x32_bf16 v[52:55], v[116:119], v[108:111], v[52:55]
    ds_read_b64_tr_b16 v[92:93], v133 offset:32768
    v_mfma_f32_16x16x32_bf16 v[56:59], v[120:123], v[108:111], v[56:59]
    ds_read_b64_tr_b16 v[94:95], v133 offset:33792
    v_mfma_f32_16x16x32_bf16 v[12:15], v[124:127], v[96:99], v[12:15]
    v_mfma_f32_16x16x32_bf16 v[28:31], v[124:127], v[100:103], v[28:31]
    v_mfma_f32_16x16x32_bf16 v[44:47], v[124:127], v[104:107], v[44:47]
    v_mfma_f32_16x16x32_bf16 v[60:63], v[124:127], v[108:111], v[60:63]
    s_waitcnt lgkmcnt(0)
    v_mfma_f32_16x16x32_bf16 v[0:3], v[80:83], v[64:67], v[0:3]
    ds_read_b128 v[96:99], v129 offset:32768
    v_mfma_f32_16x16x32_bf16 v[16:19], v[80:83], v[68:71], v[16:19]
    ds_read_b64_tr_b16 v[112:113], v130 offset:40960
    v_mfma_f32_16x16x32_bf16 v[4:7], v[84:87], v[64:67], v[4:7]
    ds_read_b64_tr_b16 v[114:115], v130 offset:41984
    v_mfma_f32_16x16x32_bf16 v[20:23], v[84:87], v[68:71], v[20:23]
    ds_read_b128 v[100:103], v129 offset:34816
    v_mfma_f32_16x16x32_bf16 v[32:35], v[80:83], v[72:75], v[32:35]
    ds_read_b64_tr_b16 v[116:117], v131 offset:40960
    v_mfma_f32_16x16x32_bf16 v[36:39], v[84:87], v[72:75], v[36:39]
    ds_read_b64_tr_b16 v[118:119], v131 offset:41984
    v_mfma_f32_16x16x32_bf16 v[8:11], v[88:91], v[64:67], v[8:11]
    ds_read_b128 v[104:107], v129 offset:36864
    v_mfma_f32_16x16x32_bf16 v[24:27], v[88:91], v[68:71], v[24:27]
    ds_read_b64_tr_b16 v[120:121], v132 offset:40960
    v_mfma_f32_16x16x32_bf16 v[40:43], v[88:91], v[72:75], v[40:43]
    ds_read_b64_tr_b16 v[122:123], v132 offset:41984
    v_mfma_f32_16x16x32_bf16 v[48:51], v[80:83], v[76:79], v[48:51]
    ds_read_b128 v[108:111], v129 offset:38912
    v_mfma_f32_16x16x32_bf16 v[52:55], v[84:87], v[76:79], v[52:55]
    ds_read_b64_tr_b16 v[124:125], v133 offset:40960
    v_mfma_f32_16x16x32_bf16 v[56:59], v[88:91], v[76:79], v[56:59]
    ds_read_b64_tr_b16 v[126:127], v133 offset:41984
    v_mfma_f32_16x16x32_bf16 v[12:15], v[92:95], v[64:67], v[12:15]
    v_mfma_f32_16x16x32_bf16 v[28:31], v[92:95], v[68:71], v[28:31]
    v_mfma_f32_16x16x32_bf16 v[44:47], v[92:95], v[72:75], v[44:47]
    v_mfma_f32_16x16x32_bf16 v[60:63], v[92:95], v[76:79], v[60:63]
    s_waitcnt lgkmcnt(0)
    s_barrier
    v_mfma_f32_16x16x32_bf16 v[0:3], v[112:115], v[96:99], v[0:3]
    ds_read_b128 v[64:67], v128 offset:49152
    v_mfma_f32_16x16x32_bf16 v[16:19], v[112:115], v[100:103], v[16:19]
    ds_read_b64_tr_b16 v[80:81], v130 offset:49152
    v_mfma_f32_16x16x32_bf16 v[4:7], v[116:119], v[96:99], v[4:7]
    ds_read_b64_tr_b16 v[82:83], v130 offset:50176
    v_mfma_f32_16x16x32_bf16 v[20:23], v[116:119], v[100:103], v[20:23]
    ds_read_b128 v[68:71], v128 offset:51200
    v_mfma_f32_16x16x32_bf16 v[32:35], v[112:115], v[104:107], v[32:35]
    ds_read_b64_tr_b16 v[84:85], v131 offset:49152
    v_mfma_f32_16x16x32_bf16 v[36:39], v[116:119], v[104:107], v[36:39]
    ds_read_b64_tr_b16 v[86:87], v131 offset:50176
    v_mfma_f32_16x16x32_bf16 v[8:11], v[120:123], v[96:99], v[8:11]
    ds_read_b128 v[72:75], v128 offset:53248
    v_mfma_f32_16x16x32_bf16 v[24:27], v[120:123], v[100:103], v[24:27]
    ds_read_b64_tr_b16 v[88:89], v132 offset:49152
    v_mfma_f32_16x16x32_bf16 v[40:43], v[120:123], v[104:107], v[40:43]
    ds_read_b64_tr_b16 v[90:91], v132 offset:50176
    v_mfma_f32_16x16x32_bf16 v[48:51], v[112:115], v[108:111], v[48:51]
    ds_read_b128 v[76:79], v128 offset:55296
    v_mfma_f32_16x16x32_bf16 v[52:55], v[116:119], v[108:111], v[52:55]
    ds_read_b64_tr_b16 v[92:93], v133 offset:49152
    v_mfma_f32_16x16x32_bf16 v[56:59], v[120:123], v[108:111], v[56:59]
    ds_read_b64_tr_b16 v[94:95], v133 offset:50176
    v_mfma_f32_16x16x32_bf16 v[12:15], v[124:127], v[96:99], v[12:15]
    v_mfma_f32_16x16x32_bf16 v[28:31], v[124:127], v[100:103], v[28:31]
    v_mfma_f32_16x16x32_bf16 v[44:47], v[124:127], v[104:107], v[44:47]
    v_mfma_f32_16x16x32_bf16 v[60:63], v[124:127], v[108:111], v[60:63]
    s_waitcnt lgkmcnt(0)
    v_mfma_f32_16x16x32_bf16 v[0:3], v[80:83], v[64:67], v[0:3]
    ds_read_b128 v[96:99], v129 offset:49152
    v_mfma_f32_16x16x32_bf16 v[16:19], v[80:83], v[68:71], v[16:19]
    ds_read_b64_tr_b16 v[112:113], v130 offset:57344
    v_mfma_f32_16x16x32_bf16 v[4:7], v[84:87], v[64:67], v[4:7]
    ds_read_b64_tr_b16 v[114:115], v130 offset:58368
    v_mfma_f32_16x16x32_bf16 v[20:23], v[84:87], v[68:71], v[20:23]
    ds_read_b128 v[100:103], v129 offset:51200
    v_mfma_f32_16x16x32_bf16 v[32:35], v[80:83], v[72:75], v[32:35]
    ds_read_b64_tr_b16 v[116:117], v131 offset:57344
    v_mfma_f32_16x16x32_bf16 v[36:39], v[84:87], v[72:75], v[36:39]
    ds_read_b64_tr_b16 v[118:119], v131 offset:58368
    v_mfma_f32_16x16x32_bf16 v[8:11], v[88:91], v[64:67], v[8:11]
    ds_read_b128 v[104:107], v129 offset:53248
    v_mfma_f32_16x16x32_bf16 v[24:27], v[88:91], v[68:71], v[24:27]
    ds_read_b64_tr_b16 v[120:121], v132 offset:57344
    v_mfma_f32_16x16x32_bf16 v[40:43], v[88:91], v[72:75], v[40:43]
    ds_read_b64_tr_b16 v[122:123], v132 offset:58368
    v_mfma_f32_16x16x32_bf16 v[48:51], v[80:83], v[76:79], v[48:51]
    ds_read_b128 v[108:111], v129 offset:55296
    v_mfma_f32_16x16x32_bf16 v[52:55], v[84:87], v[76:79], v[52:55]
    ds_read_b64_tr_b16 v[124:125], v133 offset:57344
    v_mfma_f32_16x16x32_bf16 v[56:59], v[88:91], v[76:79], v[56:59]
    ds_read_b64_tr_b16 v[126:127], v133 offset:58368
    v_mfma_f32_16x16x32_bf16 v[12:15], v[92:95], v[64:67], v[12:15]
    v_mfma_f32_16x16x32_bf16 v[28:31], v[92:95], v[68:71], v[28:31]
    v_mfma_f32_16x16x32_bf16 v[44:47], v[92:95], v[72:75], v[44:47]
    v_mfma_f32_16x16x32_bf16 v[60:63], v[92:95], v[76:79], v[60:63]
    s_waitcnt lgkmcnt(0)
    s_barrier
    v_mfma_f32_16x16x32_bf16 v[0:3], v[112:115], v[96:99], v[0:3]
    ds_read_b128 v[64:67], v128 offset:0
    v_mfma_f32_16x16x32_bf16 v[16:19], v[112:115], v[100:103], v[16:19]
    ds_read_b64_tr_b16 v[80:81], v130 offset:0
    v_mfma_f32_16x16x32_bf16 v[4:7], v[116:119], v[96:99], v[4:7]
    ds_read_b64_tr_b16 v[82:83], v130 offset:1024
    v_mfma_f32_16x16x32_bf16 v[20:23], v[116:119], v[100:103], v[20:23]
    ds_read_b128 v[68:71], v128 offset:2048
    v_mfma_f32_16x16x32_bf16 v[32:35], v[112:115], v[104:107], v[32:35]
    ds_read_b64_tr_b16 v[84:85], v131 offset:0
    v_mfma_f32_16x16x32_bf16 v[36:39], v[116:119], v[104:107], v[36:39]
    ds_read_b64_tr_b16 v[86:87], v131 offset:1024
    v_mfma_f32_16x16x32_bf16 v[8:11], v[120:123], v[96:99], v[8:11]
    ds_read_b128 v[72:75], v128 offset:4096
    v_mfma_f32_16x16x32_bf16 v[24:27], v[120:123], v[100:103], v[24:27]
    ds_read_b64_tr_b16 v[88:89], v132 offset:0
    v_mfma_f32_16x16x32_bf16 v[40:43], v[120:123], v[104:107], v[40:43]
    ds_read_b64_tr_b16 v[90:91], v132 offset:1024
    v_mfma_f32_16x16x32_bf16 v[48:51], v[112:115], v[108:111], v[48:51]
    ds_read_b128 v[76:79], v128 offset:6144
    v_mfma_f32_16x16x32_bf16 v[52:55], v[116:119], v[108:111], v[52:55]
    ds_read_b64_tr_b16 v[92:93], v133 offset:0
    v_mfma_f32_16x16x32_bf16 v[56:59], v[120:123], v[108:111], v[56:59]
    ds_read_b64_tr_b16 v[94:95], v133 offset:1024
    v_mfma_f32_16x16x32_bf16 v[12:15], v[124:127], v[96:99], v[12:15]
    v_mfma_f32_16x16x32_bf16 v[28:31], v[124:127], v[100:103], v[28:31]
    v_mfma_f32_16x16x32_bf16 v[44:47], v[124:127], v[104:107], v[44:47]
    v_mfma_f32_16x16x32_bf16 v[60:63], v[124:127], v[108:111], v[60:63]
    s_waitcnt lgkmcnt(0)
    v_mfma_f32_16x16x32_bf16 v[0:3], v[80:83], v[64:67], v[0:3]
    ds_read_b128 v[96:99], v129 offset:0
    v_mfma_f32_16x16x32_bf16 v[16:19], v[80:83], v[68:71], v[16:19]
    ds_read_b64_tr_b16 v[112:113], v130 offset:8192
    v_mfma_f32_16x16x32_bf16 v[4:7], v[84:87], v[64:67], v[4:7]
    ds_read_b64_tr_b16 v[114:115], v130 offset:9216
    v_mfma_f32_16x16x32_bf16 v[20:23], v[84:87], v[68:71], v[20:23]
    ds_read_b128 v[100:103], v129 offset:2048
    v_mfma_f32_16x16x32_bf16 v[32:35], v[80:83], v[72:75], v[32:35]
    ds_read_b64_tr_b16 v[116:117], v131 offset:8192
    v_mfma_f32_16x16x32_bf16 v[36:39], v[84:87], v[72:75], v[36:39]
    ds_read_b64_tr_b16 v[118:119], v131 offset:9216
    v_mfma_f32_16x16x32_bf16 v[8:11], v[88:91], v[64:67], v[8:11]
    ds_read_b128 v[104:107], v129 offset:4096
    v_mfma_f32_16x16x32_bf16 v[24:27], v[88:91], v[68:71], v[24:27]
    ds_read_b64_tr_b16 v[120:121], v132 offset:8192
    v_mfma_f32_16x16x32_bf16 v[40:43], v[88:91], v[72:75], v[40:43]
    ds_read_b64_tr_b16 v[122:123], v132 offset:9216
    v_mfma_f32_16x16x32_bf16 v[48:51], v[80:83], v[76:79], v[48:51]
    ds_read_b128 v[108:111], v129 offset:6144
    v_mfma_f32_16x16x32_bf16 v[52:55], v[84:87], v[76:79], v[52:55]
    ds_read_b64_tr_b16 v[124:125], v133 offset:8192
    v_mfma_f32_16x16x32_bf16 v[56:59], v[88:91], v[76:79], v[56:59]
    ds_read_b64_tr_b16 v[126:127], v133 offset:9216
    v_mfma_f32_16x16x32_bf16 v[12:15], v[92:95], v[64:67], v[12:15]
    v_mfma_f32_16x16x32_bf16 v[28:31], v[92:95], v[68:71], v[28:31]
    v_mfma_f32_16x16x32_bf16 v[44:47], v[92:95], v[72:75], v[44:47]
    v_mfma_f32_16x16x32_bf16 v[60:63], v[92:95], v[76:79], v[60:63]
    s_waitcnt lgkmcnt(0)
    s_barrier
    v_mfma_f32_16x16x32_bf16 v[0:3], v[112:115], v[96:99], v[0:3]
    ds_read_b128 v[64:67], v128 offset:16384
    v_mfma_f32_16x16x32_bf16 v[16:19], v[112:115], v[100:103], v[16:19]
    ds_read_b64_tr_b16 v[80:81], v130 offset:16384
    v_mfma_f32_16x16x32_bf16 v[4:7], v[116:119], v[96:99], v[4:7]
    ds_read_b64_tr_b16 v[82:83], v130 offset:17408
    v_mfma_f32_16x16x32_bf16 v[20:23], v[116:119], v[100:103], v[20:23]
    ds_read_b128 v[68:71], v128 offset:18432
    v_mfma_f32_16x16x32_bf16 v[32:35], v[112:115], v[104:107], v[32:35]
    ds_read_b64_tr_b16 v[84:85], v131 offset:16384
    v_mfma_f32_16x16x32_bf16 v[36:39], v[116:119], v[104:107], v[36:39]
    ds_read_b64_tr_b16 v[86:87], v131 offset:17408
    v_mfma_f32_16x16x32_bf16 v[8:11], v[120:123], v[96:99], v[8:11]
    ds_read_b128 v[72:75], v128 offset:20480
    v_mfma_f32_16x16x32_bf16 v[24:27], v[120:123], v[100:103], v[24:27]
    ds_read_b64_tr_b16 v[88:89], v132 offset:16384
    v_mfma_f32_16x16x32_bf16 v[40:43], v[120:123], v[104:107], v[40:43]
    ds_read_b64_tr_b16 v[90:91], v132 offset:17408
    v_mfma_f32_16x16x32_bf16 v[48:51], v[112:115], v[108:111], v[48:51]
    ds_read_b128 v[76:79], v128 offset:22528
    v_mfma_f32_16x16x32_bf16 v[52:55], v[116:119], v[108:111], v[52:55]
    ds_read_b64_tr_b16 v[92:93], v133 offset:16384
    v_mfma_f32_16x16x32_bf16 v[56:59], v[120:123], v[108:111], v[56:59]
    ds_read_b64_tr_b16 v[94:95], v133 offset:17408
    v_mfma_f32_16x16x32_bf16 v[12:15], v[124:127], v[96:99], v[12:15]
    v_mfma_f32_16x16x32_bf16 v[28:31], v[124:127], v[100:103], v[28:31]
    v_mfma_f32_16x16x32_bf16 v[44:47], v[124:127], v[104:107], v[44:47]
    v_mfma_f32_16x16x32_bf16 v[60:63], v[124:127], v[108:111], v[60:63]
    s_waitcnt lgkmcnt(0)
    v_mfma_f32_16x16x32_bf16 v[0:3], v[80:83], v[64:67], v[0:3]
    ds_read_b128 v[96:99], v129 offset:16384
    v_mfma_f32_16x16x32_bf16 v[16:19], v[80:83], v[68:71], v[16:19]
    ds_read_b64_tr_b16 v[112:113], v130 offset:24576
    v_mfma_f32_16x16x32_bf16 v[4:7], v[84:87], v[64:67], v[4:7]
    ds_read_b64_tr_b16 v[114:115], v130 offset:25600
    v_mfma_f32_16x16x32_bf16 v[20:23], v[84:87], v[68:71], v[20:23]
    ds_read_b128 v[100:103], v129 offset:18432
    v_mfma_f32_16x16x32_bf16 v[32:35], v[80:83], v[72:75], v[32:35]
    ds_read_b64_tr_b16 v[116:117], v131 offset:24576
    v_mfma_f32_16x16x32_bf16 v[36:39], v[84:87], v[72:75], v[36:39]
    ds_read_b64_tr_b16 v[118:119], v131 offset:25600
    v_mfma_f32_16x16x32_bf16 v[8:11], v[88:91], v[64:67], v[8:11]
    ds_read_b128 v[104:107], v129 offset:20480
    v_mfma_f32_16x16x32_bf16 v[24:27], v[88:91], v[68:71], v[24:27]
    ds_read_b64_tr_b16 v[120:121], v132 offset:24576
    v_mfma_f32_16x16x32_bf16 v[40:43], v[88:91], v[72:75], v[40:43]
    ds_read_b64_tr_b16 v[122:123], v132 offset:25600
    v_mfma_f32_16x16x32_bf16 v[48:51], v[80:83], v[76:79], v[48:51]
    ds_read_b128 v[108:111], v129 offset:22528
    v_mfma_f32_16x16x32_bf16 v[52:55], v[84:87], v[76:79], v[52:55]
    ds_read_b64_tr_b16 v[124:125], v133 offset:24576
    v_mfma_f32_16x16x32_bf16 v[56:59], v[88:91], v[76:79], v[56:59]
    ds_read_b64_tr_b16 v[126:127], v133 offset:25600
    v_mfma_f32_16x16x32_bf16 v[12:15], v[92:95], v[64:67], v[12:15]
    v_mfma_f32_16x16x32_bf16 v[28:31], v[92:95], v[68:71], v[28:31]
    v_mfma_f32_16x16x32_bf16 v[44:47], v[92:95], v[72:75], v[44:47]
    v_mfma_f32_16x16x32_bf16 v[60:63], v[92:95], v[76:79], v[60:63]
    s_waitcnt lgkmcnt(0)
    s_barrier
    v_mfma_f32_16x16x32_bf16 v[0:3], v[112:115], v[96:99], v[0:3]
    ds_read_b128 v[64:67], v128 offset:32768
    v_mfma_f32_16x16x32_bf16 v[16:19], v[112:115], v[100:103], v[16:19]
    ds_read_b64_tr_b16 v[80:81], v130 offset:32768
    v_mfma_f32_16x16x32_bf16 v[4:7], v[116:119], v[96:99], v[4:7]
    ds_read_b64_tr_b16 v[82:83], v130 offset:33792
    v_mfma_f32_16x16x32_bf16 v[20:23], v[116:119], v[100:103], v[20:23]
    ds_read_b128 v[68:71], v128 offset:34816
    v_mfma_f32_16x16x32_bf16 v[32:35], v[112:115], v[104:107], v[32:35]
    ds_read_b64_tr_b16 v[84:85], v131 offset:32768
    v_mfma_f32_16x16x32_bf16 v[36:39], v[116:119], v[104:107], v[36:39]
    ds_read_b64_tr_b16 v[86:87], v131 offset:33792
    v_mfma_f32_16x16x32_bf16 v[8:11], v[120:123], v[96:99], v[8:11]
    ds_read_b128 v[72:75], v128 offset:36864
    v_mfma_f32_16x16x32_bf16 v[24:27], v[120:123], v[100:103], v[24:27]
    ds_read_b64_tr_b16 v[88:89], v132 offset:32768
    v_mfma_f32_16x16x32_bf16 v[40:43], v[120:123], v[104:107], v[40:43]
    ds_read_b64_tr_b16 v[90:91], v132 offset:33792
    v_mfma_f32_16x16x32_bf16 v[48:51], v[112:115], v[108:111], v[48:51]
    ds_read_b128 v[76:79], v128 offset:38912
    v_mfma_f32_16x16x32_bf16 v[52:55], v[116:119], v[108:111], v[52:55]
    ds_read_b64_tr_b16 v[92:93], v133 offset:32768
    v_mfma_f32_16x16x32_bf16 v[56:59], v[120:123], v[108:111], v[56:59]
    ds_read_b64_tr_b16 v[94:95], v133 offset:33792
    v_mfma_f32_16x16x32_bf16 v[12:15], v[124:127], v[96:99], v[12:15]
    v_mfma_f32_16x16x32_bf16 v[28:31], v[124:127], v[100:103], v[28:31]
    v_mfma_f32_16x16x32_bf16 v[44:47], v[124:127], v[104:107], v[44:47]
    v_mfma_f32_16x16x32_bf16 v[60:63], v[124:127], v[108:111], v[60:63]
    s_lshl_b32 s79, s64, 2
    buffer_load_dword v152, off, s[44:47], s79 offset:128 sc0 sc1
    s_waitcnt lgkmcnt(0)
    v_mfma_f32_16x16x32_bf16 v[0:3], v[80:83], v[64:67], v[0:3]
    ds_read_b128 v[96:99], v129 offset:32768
    v_mfma_f32_16x16x32_bf16 v[16:19], v[80:83], v[68:71], v[16:19]
    ds_read_b64_tr_b16 v[112:113], v130 offset:40960
    v_mfma_f32_16x16x32_bf16 v[4:7], v[84:87], v[64:67], v[4:7]
    ds_read_b64_tr_b16 v[114:115], v130 offset:41984
    v_mfma_f32_16x16x32_bf16 v[20:23], v[84:87], v[68:71], v[20:23]
    ds_read_b128 v[100:103], v129 offset:34816
    v_mfma_f32_16x16x32_bf16 v[32:35], v[80:83], v[72:75], v[32:35]
    ds_read_b64_tr_b16 v[116:117], v131 offset:40960
    v_mfma_f32_16x16x32_bf16 v[36:39], v[84:87], v[72:75], v[36:39]
    ds_read_b64_tr_b16 v[118:119], v131 offset:41984
    v_mfma_f32_16x16x32_bf16 v[8:11], v[88:91], v[64:67], v[8:11]
    ds_read_b128 v[104:107], v129 offset:36864
    v_mfma_f32_16x16x32_bf16 v[24:27], v[88:91], v[68:71], v[24:27]
    ds_read_b64_tr_b16 v[120:121], v132 offset:40960
    v_mfma_f32_16x16x32_bf16 v[40:43], v[88:91], v[72:75], v[40:43]
    ds_read_b64_tr_b16 v[122:123], v132 offset:41984
    v_mfma_f32_16x16x32_bf16 v[48:51], v[80:83], v[76:79], v[48:51]
    ds_read_b128 v[108:111], v129 offset:38912
    v_mfma_f32_16x16x32_bf16 v[52:55], v[84:87], v[76:79], v[52:55]
    ds_read_b64_tr_b16 v[124:125], v133 offset:40960
    v_mfma_f32_16x16x32_bf16 v[56:59], v[88:91], v[76:79], v[56:59]
    ds_read_b64_tr_b16 v[126:127], v133 offset:41984
    v_mfma_f32_16x16x32_bf16 v[12:15], v[92:95], v[64:67], v[12:15]
    v_mfma_f32_16x16x32_bf16 v[28:31], v[92:95], v[68:71], v[28:31]
    v_mfma_f32_16x16x32_bf16 v[44:47], v[92:95], v[72:75], v[44:47]
    v_mfma_f32_16x16x32_bf16 v[60:63], v[92:95], v[76:79], v[60:63]
    s_waitcnt lgkmcnt(0)
    s_barrier
    v_mfma_f32_16x16x32_bf16 v[0:3], v[112:115], v[96:99], v[0:3]
    ds_read_b128 v[64:67], v128 offset:49152
    v_mfma_f32_16x16x32_bf16 v[16:19], v[112:115], v[100:103], v[16:19]
    ds_read_b64_tr_b16 v[80:81], v130 offset:49152
    ds_read_b64_tr_b16 v[82:83], v130 offset:50176
    v_mfma_f32_16x16x32_bf16 v[4:7], v[116:119], v[96:99], v[4:7]
    ds_read_b64_tr_b16 v[84:85], v131 offset:49152
    ds_read_b64_tr_b16 v[86:87], v131 offset:50176
    v_mfma_f32_16x16x32_bf16 v[20:23], v[116:119], v[100:103], v[20:23]
    ds_read_b64_tr_b16 v[88:89], v132 offset:49152
    v_mfma_f32_16x16x32_bf16 v[32:35], v[112:115], v[104:107], v[32:35]
    ds_read_b64_tr_b16 v[90:91], v132 offset:50176
    ds_read_b64_tr_b16 v[92:93], v133 offset:49152
    v_mfma_f32_16x16x32_bf16 v[36:39], v[116:119], v[104:107], v[36:39]
    ds_read_b64_tr_b16 v[94:95], v133 offset:50176
    ds_read_b128 v[68:71], v129 offset:49152
    v_mfma_f32_16x16x32_bf16 v[8:11], v[120:123], v[96:99], v[8:11]
    ds_read_b64_tr_b16 v[160:161], v130 offset:57344
    v_mfma_f32_16x16x32_bf16 v[24:27], v[120:123], v[100:103], v[24:27]
    ds_read_b64_tr_b16 v[162:163], v130 offset:58368
    ds_read_b64_tr_b16 v[164:165], v131 offset:57344
    v_mfma_f32_16x16x32_bf16 v[40:43], v[120:123], v[104:107], v[40:43]
    ds_read_b64_tr_b16 v[166:167], v131 offset:58368
    ds_read_b64_tr_b16 v[168:169], v132 offset:57344
    v_mfma_f32_16x16x32_bf16 v[48:51], v[112:115], v[108:111], v[48:51]
    ds_read_b64_tr_b16 v[170:171], v132 offset:58368
    v_mfma_f32_16x16x32_bf16 v[52:55], v[116:119], v[108:111], v[52:55]
    ds_read_b64_tr_b16 v[172:173], v133 offset:57344
    ds_read_b64_tr_b16 v[174:175], v133 offset:58368
    v_mfma_f32_16x16x32_bf16 v[56:59], v[120:123], v[108:111], v[56:59]
    ds_read_b128 v[72:75], v128 offset:0
    ds_read_b64_tr_b16 v[176:177], v130 offset:0
    v_mfma_f32_16x16x32_bf16 v[12:15], v[124:127], v[96:99], v[12:15]
    ds_read_b64_tr_b16 v[178:179], v130 offset:1024
    v_mfma_f32_16x16x32_bf16 v[28:31], v[124:127], v[100:103], v[28:31]
    ds_read_b64_tr_b16 v[180:181], v131 offset:0
    ds_read_b64_tr_b16 v[182:183], v131 offset:1024
    v_mfma_f32_16x16x32_bf16 v[44:47], v[124:127], v[104:107], v[44:47]
    ds_read_b64_tr_b16 v[184:185], v132 offset:0
    ds_read_b64_tr_b16 v[186:187], v132 offset:1024
    v_mfma_f32_16x16x32_bf16 v[60:63], v[124:127], v[108:111], v[60:63]
    ds_read_b64_tr_b16 v[188:189], v133 offset:0
    ds_read_b64_tr_b16 v[190:191], v133 offset:1024
    s_lshl_b32 s77, s64, 18
    s_lshl_b32 s70, s73, 17
    s_add_u32 s77, s77, s70
    s_lshl_b32 s70, s65, 13
    s_add_u32 s77, s77, s70
    s_lshl_b32 s70, s66, 12
    s_add_u32 s77, s77, s70
    s_lshl_b32 s70, s74, 11
    s_add_u32 s77, s77, s70
    s_lshl_b32 s75, s64, 1
    s_add_u32 s75, s75, s66
    s_lshl_b32 s75, s75, 2
    s_add_u32 s75, s75, s72
    s_lshl_b32 s75, s75, 7
    s_lshl_b32 s71, s65, 2
    s_add_u32 s75, s75, s71
    s_add_u32 s75, s75, 8388608
    s_waitcnt lgkmcnt(15)
    v_mfma_f32_16x16x32_bf16 v[0:3], v[80:83], v[64:67], v[0:3]
    ds_read_b128 v[76:79], v129 offset:0
    ds_read_b64_tr_b16 v[192:193], v130 offset:8192
    v_mfma_f32_16x16x32_bf16 v[4:7], v[84:87], v[64:67], v[4:7]
    ds_read_b64_tr_b16 v[194:195], v130 offset:9216
    ds_read_b64_tr_b16 v[196:197], v131 offset:8192
    v_mfma_f32_16x16x32_bf16 v[8:11], v[88:91], v[64:67], v[8:11]
    ds_read_b64_tr_b16 v[198:199], v131 offset:9216
    ds_read_b64_tr_b16 v[200:201], v132 offset:8192
    v_mfma_f32_16x16x32_bf16 v[12:15], v[92:95], v[64:67], v[12:15]
    ds_read_b64_tr_b16 v[202:203], v132 offset:9216
    ds_read_b64_tr_b16 v[204:205], v133 offset:8192
    s_waitcnt lgkmcnt(15)
    v_mfma_f32_16x16x32_bf16 v[0:3], v[160:163], v[68:71], v[0:3]
    ds_read_b64_tr_b16 v[206:207], v133 offset:9216
    v_mfma_f32_16x16x32_bf16 v[4:7], v[164:167], v[68:71], v[4:7]
    v_mfma_f32_16x16x32_bf16 v[8:11], v[168:171], v[68:71], v[8:11]
    v_mfma_f32_16x16x32_bf16 v[12:15], v[172:175], v[68:71], v[12:15]
    s_waitcnt lgkmcnt(9)
    v_mfma_f32_16x16x32_bf16 v[0:3], v[176:179], v[72:75], v[0:3]
    ds_read_b128 v[208:211], v128 offset:51200
    v_mfma_f32_16x16x32_bf16 v[4:7], v[180:183], v[72:75], v[4:7]
    ds_read_b128 v[212:215], v129 offset:51200
    v_mfma_f32_16x16x32_bf16 v[8:11], v[184:187], v[72:75], v[8:11]
    ds_read_b128 v[216:219], v128 offset:2048
    v_mfma_f32_16x16x32_bf16 v[12:15], v[188:191], v[72:75], v[12:15]
    ds_read_b128 v[220:223], v129 offset:2048
    s_waitcnt lgkmcnt(12)
    s_waitcnt lgkmcnt(4)
    v_mfma_f32_16x16x32_bf16 v[0:3], v[192:195], v[76:79], v[0:3]
    s_waitcnt vmcnt(0)
    v_readfirstlane_b32 s78, v152
    s_cmp_lg_u32 s78, 0
    s_cbranch_scc1 Lnn__recsys_NWC_x
    s_mov_b32 s71, 200000
    s_lshl_b32 s79, s64, 2
Lnn__recsys_NWC:
    buffer_load_dword v152, off, s[44:47], s79 offset:128 sc0 sc1
    s_waitcnt vmcnt(0)
    v_readfirstlane_b32 s78, v152
    s_sub_u32 s71, s71, 1
    s_cmp_eq_u32 s71, 0
    s_cbranch_scc1 Lnn__recsys_NWC_x
    s_cmp_eq_u32 s78, 0
    s_cbranch_scc1 Lnn__recsys_NWC
Lnn__recsys_NWC_x:
    v_mfma_f32_16x16x32_bf16 v[4:7], v[196:199], v[76:79], v[4:7]
    v_mfma_f32_16x16x32_bf16 v[8:11], v[200:203], v[76:79], v[8:11]
    v_mfma_f32_16x16x32_bf16 v[12:15], v[204:207], v[76:79], v[12:15]
    s_waitcnt lgkmcnt(3)
    v_mfma_f32_16x16x32_bf16 v[16:19], v[80:83], v[208:211], v[16:19]
    ds_read_b128 v[64:67], v128 offset:53248
    v_mfma_f32_16x16x32_bf16 v[20:23], v[84:87], v[208:211], v[20:23]
    ds_read_b128 v[68:71], v129 offset:53248
    v_mfma_f32_16x16x32_bf16 v[24:27], v[88:91], v[208:211], v[24:27]
    ds_read_b128 v[72:75], v128 offset:4096
    v_cvt_pk_bf16_f32 v96, v0, v1
    v_cvt_pk_bf16_f32 v97, v2, v3
    v_mfma_f32_16x16x32_bf16 v[28:31], v[92:95], v[208:211], v[28:31]
    ds_read_b128 v[76:79], v129 offset:4096
    v_cvt_pk_bf16_f32 v98, v4, v5
    v_cvt_pk_bf16_f32 v99, v6, v7
    s_waitcnt lgkmcnt(6)
    v_mfma_f32_16x16x32_bf16 v[16:19], v[160:163], v[212:215], v[16:19]
    s_cmp_eq_u32 s62, 0
    s_cbranch_scc1 Lnn__recsys_SK00
    buffer_store_dwordx4 v[96:99], v134, s[40:43], s77 offen offset:0 sc0 sc1
Lnn__recsys_SK00:
    v_cvt_pk_bf16_f32 v100, v8, v9
    v_mfma_f32_16x16x32_bf16 v[20:23], v[164:167], v[212:215], v[20:23]
    v_cvt_pk_bf16_f32 v101, v10, v11
    v_cvt_pk_bf16_f32 v102, v12, v13
    v_mfma_f32_16x16x32_bf16 v[24:27], v[168:171], v[212:215], v[24:27]
    v_cvt_pk_bf16_f32 v103, v14, v15
    s_cmp_eq_u32 s62, 0
    s_cbranch_scc1 Lnn__recsys_SK01
    buffer_store_dwordx4 v[100:103], v134, s[40:43], s77 offen offset:1024 sc0 sc1
Lnn__recsys_SK01:
    v_mfma_f32_16x16x32_bf16 v[28:31], v[172:175], v[212:215], v[28:31]
    s_waitcnt lgkmcnt(5)
    v_mfma_f32_16x16x32_bf16 v[16:19], v[176:179], v[216:219], v[16:19]
    v_mfma_f32_16x16x32_bf16 v[20:23], v[180:183], v[216:219], v[20:23]
    v_mfma_f32_16x16x32_bf16 v[24:27], v[184:187], v[216:219], v[24:27]
    v_mfma_f32_16x16x32_bf16 v[28:31], v[188:191], v[216:219], v[28:31]
    s_waitcnt lgkmcnt(4)
    v_mfma_f32_16x16x32_bf16 v[16:19], v[192:195], v[220:223], v[16:19]
    v_mfma_f32_16x16x32_bf16 v[20:23], v[196:199], v[220:223], v[20:23]
    v_mfma_f32_16x16x32_bf16 v[24:27], v[200:203], v[220:223], v[24:27]
    v_mfma_f32_16x16x32_bf16 v[28:31], v[204:207], v[220:223], v[28:31]
    s_waitcnt lgkmcnt(3)
    v_mfma_f32_16x16x32_bf16 v[32:35], v[80:83], v[64:67], v[32:35]
    ds_read_b128 v[208:211], v128 offset:55296
    v_mfma_f32_16x16x32_bf16 v[36:39], v[84:87], v[64:67], v[36:39]
    ds_read_b128 v[212:215], v129 offset:55296
    v_mfma_f32_16x16x32_bf16 v[40:43], v[88:91], v[64:67], v[40:43]
    ds_read_b128 v[216:219], v128 offset:6144
    s_add_u32 s77, s77, 32768
    v_cvt_pk_bf16_f32 v104, v16, v17
    v_mfma_f32_16x16x32_bf16 v[44:47], v[92:95], v[64:67], v[44:47]
    ds_read_b128 v[220:223], v129 offset:6144
    v_cvt_pk_bf16_f32 v105, v18, v19
    v_cvt_pk_bf16_f32 v106, v20, v21
    s_waitcnt lgkmcnt(6)
    v_mfma_f32_16x16x32_bf16 v[32:35], v[160:163], v[68:71], v[32:35]
    v_cvt_pk_bf16_f32 v107, v22, v23
    s_cmp_eq_u32 s62, 1
    s_cbranch_scc1 Lnn__recsys_SK10
    buffer_store_dwordx4 v[104:107], v134, s[40:43], s77 offen offset:0 sc0 sc1
Lnn__recsys_SK10:
    v_mfma_f32_16x16x32_bf16 v[36:39], v[164:167], v[68:71], v[36:39]
    v_cvt_pk_bf16_f32 v108, v24, v25
    v_cvt_pk_bf16_f32 v109, v26, v27
    v_mfma_f32_16x16x32_bf16 v[40:43], v[168:171], v[68:71], v[40:43]
    v_cvt_pk_bf16_f32 v110, v28, v29
    v_cvt_pk_bf16_f32 v111, v30, v31
    v_mfma_f32_16x16x32_bf16 v[44:47], v[172:175], v[68:71], v[44:47]
    s_cmp_eq_u32 s62, 1
    s_cbranch_scc1 Lnn__recsys_SK11
    buffer_store_dwordx4 v[108:111], v134, s[40:43], s77 offen offset:1024 sc0 sc1
Lnn__recsys_SK11:
    s_waitcnt lgkmcnt(5)
    v_mfma_f32_16x16x32_bf16 v[32:35], v[176:179], v[72:75], v[32:35]
    v_mfma_f32_16x16x32_bf16 v[36:39], v[180:183], v[72:75], v[36:39]
    v_mfma_f32_16x16x32_bf16 v[40:43], v[184:187], v[72:75], v[40:43]
    v_mfma_f32_16x16x32_bf16 v[44:47], v[188:191], v[72:75], v[44:47]
    s_waitcnt lgkmcnt(4)
    v_mfma_f32_16x16x32_bf16 v[32:35], v[192:195], v[76:79], v[32:35]
    v_mfma_f32_16x16x32_bf16 v[36:39], v[196:199], v[76:79], v[36:39]
    v_mfma_f32_16x16x32_bf16 v[40:43], v[200:203], v[76:79], v[40:43]
    v_mfma_f32_16x16x32_bf16 v[44:47], v[204:207], v[76:79], v[44:47]
    s_waitcnt lgkmcnt(3)
    v_mfma_f32_16x16x32_bf16 v[48:51], v[80:83], v[208:211], v[48:51]
    v_mfma_f32_16x16x32_bf16 v[52:55], v[84:87], v[208:211], v[52:55]
    v_mfma_f32_16x16x32_bf16 v[56:59], v[88:91], v[208:211], v[56:59]
    s_add_u32 s77, s77, 32768
    v_cvt_pk_bf16_f32 v112, v32, v33
    v_mfma_f32_16x16x32_bf16 v[60:63], v[92:95], v[208:211], v[60:63]
    v_cvt_pk_bf16_f32 v113, v34, v35
    v_cvt_pk_bf16_f32 v114, v36, v37
    s_waitcnt lgkmcnt(2)
    v_mfma_f32_16x16x32_bf16 v[48:51], v[160:163], v[212:215], v[48:51]
    v_cvt_pk_bf16_f32 v115, v38, v39
    s_cmp_eq_u32 s62, 2
    s_cbranch_scc1 Lnn__recsys_SK20
    buffer_store_dwordx4 v[112:115], v134, s[40:43], s77 offen offset:0 sc0 sc1
Lnn__recsys_SK20:
    v_mfma_f32_16x16x32_bf16 v[52:55], v[164:167], v[212:215], v[52:55]
    v_cvt_pk_bf16_f32 v116, v40, v41
    v_cvt_pk_bf16_f32 v117, v42, v43
    v_mfma_f32_16x16x32_bf16 v[56:59], v[168:171], v[212:215], v[56:59]
    v_cvt_pk_bf16_f32 v118, v44, v45
    v_cvt_pk_bf16_f32 v119, v46, v47
    v_mfma_f32_16x16x32_bf16 v[60:63], v[172:175], v[212:215], v[60:63]
    s_cmp_eq_u32 s62, 2
    s_cbranch_scc1 Lnn__recsys_SK21
    buffer_store_dwordx4 v[116:119], v134, s[40:43], s77 offen offset:1024 sc0 sc1
Lnn__recsys_SK21:
    s_waitcnt lgkmcnt(1)
    v_mfma_f32_16x16x32_bf16 v[48:51], v[176:179], v[216:219], v[48:51]
    v_mfma_f32_16x16x32_bf16 v[52:55], v[180:183], v[216:219], v[52:55]
    v_mfma_f32_16x16x32_bf16 v[56:59], v[184:187], v[216:219], v[56:59]
    v_mfma_f32_16x16x32_bf16 v[60:63], v[188:191], v[216:219], v[60:63]
    s_waitcnt lgkmcnt(0)
    v_mfma_f32_16x16x32_bf16 v[48:51], v[192:195], v[220:223], v[48:51]
    v_mfma_f32_16x16x32_bf16 v[52:55], v[196:199], v[220:223], v[52:55]
    v_mfma_f32_16x16x32_bf16 v[56:59], v[200:203], v[220:223], v[56:59]
    v_mfma_f32_16x16x32_bf16 v[60:63], v[204:207], v[220:223], v[60:63]
    v_mov_b32 v150, s78
    s_add_u32 s77, s77, 32768
    s_nop 2
    v_cvt_pk_bf16_f32 v120, v48, v49
    v_cvt_pk_bf16_f32 v121, v50, v51
    v_cvt_pk_bf16_f32 v122, v52, v53
    v_cvt_pk_bf16_f32 v123, v54, v55
    s_cmp_eq_u32 s62, 3
    s_cbranch_scc1 Lnn__recsys_SK30
    buffer_store_dwordx4 v[120:123], v134, s[40:43], s77 offen offset:0 sc0 sc1
Lnn__recsys_SK30:
    v_cvt_pk_bf16_f32 v124, v56, v57
    v_cvt_pk_bf16_f32 v125, v58, v59
    v_cvt_pk_bf16_f32 v126, v60, v61
    v_cvt_pk_bf16_f32 v127, v62, v63
    s_cmp_eq_u32 s62, 3
    s_cbranch_scc1 Lnn__recsys_SK31
    buffer_store_dwordx4 v[124:127], v134, s[40:43], s77 offen offset:1024 sc0 sc1
Lnn__recsys_SK31:
    s_mov_b64 exec, 1
    s_waitcnt vmcnt(0)
    buffer_store_dword v150, off, s[40:43], s75 sc0 sc1
    s_mov_b64 exec, -1
    s_lshl_b32 s77, s64, 18
    s_lshl_b32 s71, s67, 15
    s_add_u32 s77, s77, s71
    s_lshl_b32 s71, s61, 11
    s_add_u32 s77, s77, s71
    v_mov_b32 v200, 0
    s_mov_b32 s71, 200000
    s_lshl_b32 s70, s64, 1
    s_lshr_b32 s75, s61, 1
    s_add_u32 s70, s70, s75
    s_lshl_b32 s70, s70, 2
    s_add_u32 s70, s70, s66
    s_and_b32 s75, s61, 1
    s_lshl_b32 s75, s75, 1
    s_add_u32 s70, s70, s75
    s_lshl_b32 s70, s70, 7
    s_add_u32 s70, s70, 8388608
    s_mov_b64 exec, 1
    s_mov_b64 exec, -1
    s_mov_b32 s56, s18
    s_mov_b32 s57, s19
    s_mov_b32 s58, 8192
    s_mov_b32 s59, 0x20000
    s_mov_b32 s79, 0xffff0000
    s_add_u32 s63, s65, 1
    s_and_b32 s63, s63, 3
    s_lshl_b32 s63, s63, 13
    s_add_u32 s74, s77, s63
    s_add_u32 s63, s65, 2
    s_and_b32 s63, s63, 3
    s_lshl_b32 s63, s63, 13
    s_add_u32 s75, s77, s63
    s_add_u32 s63, s65, 3
    s_and_b32 s63, s63, 3
    s_lshl_b32 s63, s63, 13
    s_add_u32 s76, s77, s63
    s_lshl_b32 s63, s65, 13
    s_add_u32 s77, s77, s63
    s_mov_b32 s52, s16
    s_mov_b32 s53, s17
    s_mov_b32 s54, 2
    s_mov_b32 s55, 0x20000
    v_mov_b32 v96, 0
    v_mov_b32 v97, 0xbdd2d3e8
    s_mov_b64 exec, 1
    s_waitcnt vmcnt(0)
Lnn__recsys_POLL:
    buffer_load_dwordx4 v[204:207], off, s[40:43], s70 sc1
Lnn__recsys_POLLT:
    s_sub_u32 s71, s71, 1
    s_cmp_eq_u32 s71, 0
    s_cbranch_scc1 Lnn__recsys_POLLED
    s_waitcnt vmcnt(0)
Lnn__recsys_POLLU:
    v_xor_b32 v204, s78, v204
    v_xor_b32 v205, s78, v205
    v_xor_b32 v206, s78, v206
    v_xor_b32 v207, s78, v207
    v_or3_b32 v204, v204, v205, v206
    v_or_b32 v204, v204, v207
    v_cmp_ne_u32 vcc, 0, v204
    s_cbranch_vccnz Lnn__recsys_POLL
Lnn__recsys_POLLED:
    s_mov_b64 exec, -1
    s_cmp_lt_u32 s62, 4
    s_cbranch_scc1 Lnn__recsys_OL
    buffer_load_dwordx4 v[160:163], v134, s[40:43], s77 offen offset:0 sc1
    buffer_load_dwordx4 v[164:167], v134, s[40:43], s77 offen offset:1024 sc1
Lnn__recsys_OL:
    buffer_load_dwordx4 v[168:171], v134, s[40:43], s74 offen offset:0 sc1
    buffer_load_dwordx4 v[172:175], v134, s[40:43], s74 offen offset:1024 sc1
    buffer_load_dwordx4 v[176:179], v134, s[40:43], s75 offen offset:0 sc1
    buffer_load_dwordx4 v[180:183], v134, s[40:43], s75 offen offset:1024 sc1
    buffer_load_dwordx4 v[184:187], v134, s[40:43], s76 offen offset:0 sc1
    buffer_load_dwordx4 v[188:191], v134, s[40:43], s76 offen offset:1024 sc1
    buffer_load_short_d16_hi v96, v200, s[52:55], 0 offen
    s_cbranch_scc1 Lnn__recsys_OA
    s_waitcnt vmcnt(7)
    v_mfma_f32_16x16x32_bf16 v[0:3], v[240:243], v[160:163], 0
    v_mfma_f32_16x16x32_bf16 v[4:7], v[242:245], v[160:163], 0
    v_mfma_f32_16x16x32_bf16 v[8:11], v[240:243], v[164:167], 0
    v_mfma_f32_16x16x32_bf16 v[12:15], v[242:245], v[164:167], 0
Lnn__recsys_OQ0:
    s_waitcnt vmcnt(5)
    v_mfma_f32_16x16x32_bf16 v[0:3], v[240:243], v[168:171], v[0:3]
    v_mfma_f32_16x16x32_bf16 v[4:7], v[242:245], v[168:171], v[4:7]
    v_mfma_f32_16x16x32_bf16 v[8:11], v[240:243], v[172:175], v[8:11]
    v_mfma_f32_16x16x32_bf16 v[12:15], v[242:245], v[172:175], v[12:15]
Lnn__recsys_OQD:
    s_waitcnt vmcnt(3)
    v_mfma_f32_16x16x32_bf16 v[0:3], v[240:243], v[176:179], v[0:3]
    v_mfma_f32_16x16x32_bf16 v[4:7], v[242:245], v[176:179], v[4:7]
    v_mfma_f32_16x16x32_bf16 v[8:11], v[240:243], v[180:183], v[8:11]
    v_mfma_f32_16x16x32_bf16 v[12:15], v[242:245], v[180:183], v[12:15]
    s_waitcnt vmcnt(1)
    v_mfma_f32_16x16x32_bf16 v[0:3], v[240:243], v[184:187], v[0:3]
    v_mfma_f32_16x16x32_bf16 v[4:7], v[242:245], v[184:187], v[4:7]
    v_mfma_f32_16x16x32_bf16 v[8:11], v[240:243], v[188:191], v[8:11]
    v_mfma_f32_16x16x32_bf16 v[12:15], v[242:245], v[188:191], v[12:15]
    s_nop 4
    v_pk_mul_f32 v[64:65], v[0:1], v[0:1]
    v_pk_mul_f32 v[66:67], v[2:3], v[2:3]
    v_pk_mul_f32 v[68:69], v[4:5], v[4:5]
    v_pk_mul_f32 v[70:71], v[6:7], v[6:7]
    v_pk_mul_f32 v[72:73], v[8:9], v[8:9]
    v_pk_mul_f32 v[74:75], v[10:11], v[10:11]
    v_pk_mul_f32 v[76:77], v[12:13], v[12:13]
    v_pk_mul_f32 v[78:79], v[14:15], v[14:15]
    v_pk_fma_f32 v[64:65], v[64:65], v[232:233], v[232:233] op_sel:[0,0,1] op_sel_hi:[1,0,1]
    v_pk_fma_f32 v[66:67], v[66:67], v[232:233], v[232:233] op_sel:[0,0,1] op_sel_hi:[1,0,1]
    v_pk_fma_f32 v[68:69], v[68:69], v[232:233], v[232:233] op_sel:[0,0,1] op_sel_hi:[1,0,1]
    v_pk_fma_f32 v[70:71], v[70:71], v[232:233], v[232:233] op_sel:[0,0,1] op_sel_hi:[1,0,1]
    v_pk_fma_f32 v[72:73], v[72:73], v[232:233], v[232:233] op_sel:[0,0,1] op_sel_hi:[1,0,1]
    v_pk_fma_f32 v[74:75], v[74:75], v[232:233], v[232:233] op_sel:[0,0,1] op_sel_hi:[1,0,1]
    v_pk_fma_f32 v[76:77], v[76:77], v[232:233], v[232:233] op_sel:[0,0,1] op_sel_hi:[1,0,1]
    v_pk_fma_f32 v[78:79], v[78:79], v[232:233], v[232:233] op_sel:[0,0,1] op_sel_hi:[1,0,1]
    v_pk_mul_f32 v[64:65], v[64:65], v[0:1]
    v_pk_mul_f32 v[66:67], v[66:67], v[2:3]
    v_pk_mul_f32 v[68:69], v[68:69], v[4:5]
    v_pk_mul_f32 v[70:71], v[70:71], v[6:7]
    v_pk_mul_f32 v[72:73], v[72:73], v[8:9]
    v_pk_mul_f32 v[74:75], v[74:75], v[10:11]
    v_pk_mul_f32 v[76:77], v[76:77], v[12:13]
    v_pk_mul_f32 v[78:79], v[78:79], v[14:15]
    v_exp_f32 v64, v64
    v_exp_f32 v65, v65
    v_exp_f32 v66, v66
    v_exp_f32 v67, v67
    v_exp_f32 v68, v68
    v_exp_f32 v69, v69
    v_exp_f32 v70, v70
    v_exp_f32 v71, v71
    v_exp_f32 v72, v72
    v_exp_f32 v73, v73
    v_exp_f32 v74, v74
    v_exp_f32 v75, v75
    v_exp_f32 v76, v76
    v_exp_f32 v77, v77
    v_exp_f32 v78, v78
    v_exp_f32 v79, v79
    v_pk_add_f32 v[64:65], v[64:65], v[234:235]
    v_pk_add_f32 v[66:67], v[66:67], v[234:235]
    v_pk_add_f32 v[68:69], v[68:69], v[234:235]
    v_pk_add_f32 v[70:71], v[70:71], v[234:235]
    v_pk_add_f32 v[72:73], v[72:73], v[234:235]
    v_pk_add_f32 v[74:75], v[74:75], v[234:235]
    v_pk_add_f32 v[76:77], v[76:77], v[234:235]
    v_pk_add_f32 v[78:79], v[78:79], v[234:235]
    v_rcp_f32 v64, v64
    v_rcp_f32 v65, v65
    v_rcp_f32 v66, v66
    v_rcp_f32 v67, v67
    v_rcp_f32 v68, v68
    v_rcp_f32 v69, v69
    v_rcp_f32 v70, v70
    v_rcp_f32 v71, v71
    v_rcp_f32 v72, v72
    v_rcp_f32 v73, v73
    v_rcp_f32 v74, v74
    v_rcp_f32 v75, v75
    v_rcp_f32 v76, v76
    v_rcp_f32 v77, v77
    v_rcp_f32 v78, v78
    v_rcp_f32 v79, v79
    v_pk_mul_f32 v[0:1], v[0:1], v[64:65]
    v_pk_mul_f32 v[2:3], v[2:3], v[66:67]
    v_pk_mul_f32 v[4:5], v[4:5], v[68:69]
    v_pk_mul_f32 v[6:7], v[6:7], v[70:71]
    v_pk_mul_f32 v[8:9], v[8:9], v[72:73]
    v_pk_mul_f32 v[10:11], v[10:11], v[74:75]
    v_pk_mul_f32 v[12:13], v[12:13], v[76:77]
    v_pk_mul_f32 v[14:15], v[14:15], v[78:79]
    v_cvt_pk_bf16_f32 v80, v0, v1
    v_cvt_pk_bf16_f32 v81, v2, v3
    v_cvt_pk_bf16_f32 v82, v4, v5
    v_cvt_pk_bf16_f32 v83, v6, v7
    v_cvt_pk_bf16_f32 v84, v8, v9
    v_cvt_pk_bf16_f32 v85, v10, v11
    v_cvt_pk_bf16_f32 v86, v12, v13
    v_cvt_pk_bf16_f32 v87, v14, v15
    v_mfma_f32_16x16x32_bf16 v[88:91], v[224:227], v[80:83], 0
    s_nop 1
    v_mfma_f32_16x16x32_bf16 v[88:91], v[228:231], v[84:87], v[88:91]
    s_lshl_b32 s70, s67, 4
    s_add_u32 s70, s70, s68
    s_lshl_b32 s70, s70, 1
    s_nop 4
    ds_write_b32 v237, v88
    s_waitcnt lgkmcnt(0)
    s_barrier
    s_cmp_lg_u32 s72, 0
    s_cbranch_scc1 Lnn__recsys_END
    ds_read2_b32 v[0:1], v236 offset0:0 offset1:16
    ds_read2_b32 v[2:3], v236 offset0:32 offset1:48
    ds_read2_b32 v[4:5], v236 offset0:64 offset1:80
    ds_read2_b32 v[6:7], v236 offset0:96 offset1:112
    s_mov_b64 exec, 0xffff
    s_waitcnt lgkmcnt(2)
    v_pk_add_f32 v[0:1], v[0:1], v[2:3]
    s_waitcnt lgkmcnt(0)
    v_pk_add_f32 v[4:5], v[4:5], v[6:7]
    s_waitcnt vmcnt(0)
    v_add_f32 v0, v0, v96
    v_pk_add_f32 v[0:1], v[0:1], v[4:5]
    v_add_f32 v0, v0, v1
    v_cvt_pk_bf16_f32 v0, v0, v0
    buffer_store_short v0, v238, s[56:59], s70 offen
    s_branch Lnn__recsys_FIN
Lnn__recsys_OA:
    s_cmp_eq_u32 s62, 0
    s_cbranch_scc1 Lnn__recsys_OQ0
    s_waitcnt vmcnt(5)
    s_cmp_lg_u32 s62, 1
    s_cbranch_scc1 Lnn__recsys_OB2
    v_mfma_f32_16x16x32_bf16 v[0:3], v[240:243], v[168:171], v[16:19]
    v_mfma_f32_16x16x32_bf16 v[4:7], v[242:245], v[168:171], v[20:23]
    v_mfma_f32_16x16x32_bf16 v[8:11], v[240:243], v[172:175], v[24:27]
    v_mfma_f32_16x16x32_bf16 v[12:15], v[242:245], v[172:175], v[28:31]
    s_branch Lnn__recsys_OQD
Lnn__recsys_OB2:
    s_cmp_lg_u32 s62, 2
    s_cbranch_scc1 Lnn__recsys_OB3
    v_mfma_f32_16x16x32_bf16 v[0:3], v[240:243], v[168:171], v[32:35]
    v_mfma_f32_16x16x32_bf16 v[4:7], v[242:245], v[168:171], v[36:39]
    v_mfma_f32_16x16x32_bf16 v[8:11], v[240:243], v[172:175], v[40:43]
    v_mfma_f32_16x16x32_bf16 v[12:15], v[242:245], v[172:175], v[44:47]
    s_branch Lnn__recsys_OQD
Lnn__recsys_OB3:
    v_mfma_f32_16x16x32_bf16 v[0:3], v[240:243], v[168:171], v[48:51]
    v_mfma_f32_16x16x32_bf16 v[4:7], v[242:245], v[168:171], v[52:55]
    v_mfma_f32_16x16x32_bf16 v[8:11], v[240:243], v[172:175], v[56:59]
    v_mfma_f32_16x16x32_bf16 v[12:15], v[242:245], v[172:175], v[60:63]
    s_branch Lnn__recsys_OQD
Lnn__recsys_FIN:
Lnn__recsys_END:
    s_endpgm
.section .rodata,"a"
.p2align 6
.amdhsa_kernel standalone__deep_cross_pnn__recsys_kernel
  .amdhsa_next_free_vgpr 256
  .amdhsa_next_free_sgpr 102
  .amdhsa_accum_offset 256
  .amdhsa_group_segment_fixed_size 0
  .amdhsa_kernarg_size 80
  .amdhsa_user_sgpr_count 2
  .amdhsa_user_sgpr_kernarg_segment_ptr 1
  .amdhsa_system_sgpr_workgroup_id_x 1
.end_amdhsa_kernel
```
